```python
import torch

def _softmax(x, axis=-1):
    return torch.softmax(x, dim=axis)
def _gelu(x):
    return torch.nn.functional.gelu(x, approximate="tanh")
def _silu(x):
    return torch.nn.functional.silu(x)
def _sigmoid(x):
    return torch.sigmoid(x)
def _layernorm(x, axis=-1, eps=1e-5):
    m = x.mean(dim=axis, keepdim=True)
    v = x.var(dim=axis, keepdim=True, unbiased=False)
    return (x - m) / torch.sqrt(v + eps)
def _scatter_add(tgt, idx, src, axis=0):
    return tgt.clone().index_add_(axis, idx, src)
def _segment_sum(src, seg, n):
    out = torch.zeros((n,) + src.shape[1:], dtype=src.dtype)
    return out.index_add_(0, seg, src)
def _pad(x, pw):
    flat = tuple(v for pair in reversed(pw) for v in pair)
    return torch.nn.functional.pad(x, flat)

kernel_name = 'recurrent_scan__compressed_kv_cla__dense_activation_relu__decode'

def setup_inputs():

    _w = (lambda a: (lambda t: t.to(torch.bfloat16) if t.is_floating_point() else t)(torch.as_tensor(a)))
    def _A_setup():
        B, H, Sq, Sk, D, M = 1, 32, 1, 16384, 128, 640
        Dc = 4 * D
        return {
            "x": _w((lambda *s: torch.randn(*s, dtype=torch.bfloat16) * 0.05)(B, Sq, M)),
            "c_kv": _w((lambda *s: torch.randn(*s, dtype=torch.bfloat16) * 0.8)(B, Sk, Dc)),
            "w_q": _w((lambda *s: torch.randn(*s, dtype=torch.bfloat16) * 1.6)(M, H, D) * (M ** -0.5)),
            "w_uk": _w((lambda *s: torch.randn(*s, dtype=torch.bfloat16) * 1.6)(Dc, H, D) * (Dc ** -0.5)),
            "w_uv": _w((lambda *s: torch.randn(*s, dtype=torch.bfloat16) * 0.8)(Dc, H, D) * (Dc ** -0.5)),
            "w_o": _w((lambda *s: torch.randn(*s, dtype=torch.bfloat16) * 0.8)(H, D, M) * ((H * D) ** -0.5)),
        }
    _A_in = _A_setup()

    def _B_setup():
        B, S, D, Dff = 1, 1, 640, 1728
        return {
            "x": _w((lambda *s: torch.randn(*s, dtype=torch.bfloat16) * 0.05)(B, S, D)),
            "w1": _w((lambda *s: torch.randn(*s, dtype=torch.bfloat16) * 0.2)(D, Dff)),
            "w2": _w((lambda *s: torch.randn(*s, dtype=torch.bfloat16) * 0.2)(Dff, D)),
        }
    _B_in = _B_setup()

    return {
        "A_x": _A_in["x"],
        "A_c_kv": _A_in["c_kv"],
        "A_w_q": _A_in["w_q"],
        "A_w_uk": _A_in["w_uk"],
        "A_w_uv": _A_in["w_uv"],
        "A_w_o": _A_in["w_o"],
        "B_x": _B_in["x"],
        "B_w1": _B_in["w1"],
        "B_w2": _B_in["w2"],
    }

def reference(A_x, A_c_kv, A_w_q, A_w_uk, A_w_uv, A_w_o, B_x, B_w1, B_w2):
    def _A_ref(x, c_kv, w_q, w_uk, w_uv, w_o):
        B, Sq, M = x.shape[0], x.shape[1], x.shape[2]
        Sk = c_kv.shape[1]
        H, D = w_q.shape[1], w_q.shape[2]
        q = torch.einsum("bqm,mhd->bhqd", x, w_q)
        k = torch.einsum("bkc,chd->bhkd", c_kv, w_uk)
        v = torch.einsum("bkc,chd->bhkd", c_kv, w_uv)
        scores = torch.einsum("bhqd,bhkd->bhqk", q, k) * (D ** -0.5)
        off = Sk - Sq
        qi = torch.arange(Sq)[:, None]
        kj = torch.arange(Sk)[None, :]
        cmask = kj <= (qi + off)
        scores = torch.where(cmask[None, None], scores, -1e9)
        p = _softmax(scores, axis=-1)
        ctx = torch.einsum("bhqk,bhkd->bhqd", p, v)
        return torch.einsum("bhqd,hdm->bqm", ctx, w_o)

    def _B_ref(x, w1, w2):
        h = torch.einsum("bsd,df->bsf", x, w1)
        zero = torch.zeros_like(h)
        h = torch.maximum(h, zero)
        return torch.einsum("bsf,fd->bsd", h, w2)

    x = A_x
    xn = _layernorm(x, axis=-1)
    s = _A_ref(xn, A_c_kv, A_w_q, A_w_uk, A_w_uv, A_w_o)
    g = _silu(_B_ref(xn, B_w1, B_w2))
    return x + s * g
```

```asm
; @launch grid=(256,1,1) block=(768,1,1) lds=161792
.amdgcn_target "amdgcn-amd-amdhsa--gfx950"
.text
.globl recurrent_scan__compressed_kv_cla__dense_activation_relu__decode_kernel
.p2align 12
.type recurrent_scan__compressed_kv_cla__dense_activation_relu__decode_kernel,@function
recurrent_scan__compressed_kv_cla__dense_activation_relu__decode_kernel:
  s_load_dwordx16 s[16:31], s[0:1], 0
  s_load_dwordx8 s[32:39], s[0:1], 64
  s_cmp_ge_u32 s2, 256
  s_cbranch_scc1 L_END
  v_lshrrev_b32 v3, 6, v0
  v_and_b32 v0, 63, v0
  v_readfirstlane_b32 s3, v3
  v_mov_b32 v1, 0
  v_lshrrev_b32 v5, 4, v0
  s_cmp_eq_u32 s3, 7
  s_cbranch_scc0 L_nopf
  s_getpc_b64 s[44:45]
  L_pc:
  s_sub_u32 s44, s44, L_pc-recurrent_scan__compressed_kv_cla__dense_activation_relu__decode_kernel
  s_subb_u32 s45, s45, 0
  s_and_b32 s41, s2, 0xf8
  v_add_u32 v10, s41, v0
  v_lshlrev_b32 v10, 7, v10
  v_cmp_gt_u32 vcc, L_CODE_END-recurrent_scan__compressed_kv_cla__dense_activation_relu__decode_kernel, v10
  s_and_b64 exec, vcc, 0xff
  s_cbranch_execz L_nopf2
  global_load_dword v159, v10, s[44:45]
  L_nopf2:
  s_mov_b64 exec, -1
  L_nopf:
  v_mov_b32 v2, 1
  v_and_b32 v4, 15, v0
  s_and_b32 s12, s2, 7
  s_lshr_b32 s13, s2, 3
  s_lshr_b32 s14, s13, 3
  s_lshl_b32 s15, s12, 2
  s_add_u32 s14, s14, s15
  s_and_b32 s15, s13, 7
  s_mov_b32 s100, 0x05040100
  s_mov_b32 s101, 0x07060302
  s_cmp_ge_u32 s3, 6
  s_cbranch_scc1 L_OTH
  s_setprio 2
  v_lshlrev_b32 v24, 16, v5
  v_lshl_add_u32 v24, v4, 3, v24
  v_mul_u32_u24 v6, 20, v0
  s_lshr_b32 s40, s15, 1
  s_mul_i32 s40, s40, 160
  s_lshl_b32 s41, s3, 5
  s_add_u32 s40, s40, s41
  s_lshl_b32 s41, s40, 13
  s_lshl_b32 s42, s14, 8
  s_add_u32 s41, s41, s42
  s_and_b32 s42, s15, 1
  s_lshl_b32 s42, s42, 7
  s_add_u32 s41, s41, s42
  s_mov_b32 s46, 5242880
  s_mov_b32 s47, 0x20000
  s_mov_b32 s10, 1280
  s_mov_b32 s11, 0x20000
  s_cmp_eq_u32 s3, 5
  s_cbranch_scc0 L_A
  s_setprio 3
  s_waitcnt lgkmcnt(0)
  s_mov_b32 s8, s16
  s_mov_b32 s9, s17
  buffer_load_dwordx4 v[8:11], v6, s[8:11], 0 offen
  buffer_load_dword v12, v6, s[8:11], 0 offen offset:16
  s_barrier
  s_branch L_LN
L_A:
  s_waitcnt lgkmcnt(0)
  s_mov_b32 s44, s20
  s_mov_b32 s45, s21
  s_nop 1
  buffer_load_dwordx2 v[32:33], v24, s[44:47], s41 offen nt
  s_add_u32 s42, s41, 8192
  buffer_load_dwordx2 v[34:35], v24, s[44:47], s42 offen nt
  s_add_u32 s42, s41, 16384
  buffer_load_dwordx2 v[36:37], v24, s[44:47], s42 offen nt
  s_add_u32 s42, s41, 24576
  buffer_load_dwordx2 v[38:39], v24, s[44:47], s42 offen nt
  s_add_u32 s42, s41, 32768
  buffer_load_dwordx2 v[40:41], v24, s[44:47], s42 offen nt
  s_add_u32 s42, s41, 40960
  buffer_load_dwordx2 v[42:43], v24, s[44:47], s42 offen nt
  s_add_u32 s42, s41, 49152
  buffer_load_dwordx2 v[44:45], v24, s[44:47], s42 offen nt
  s_add_u32 s42, s41, 57344
  buffer_load_dwordx2 v[46:47], v24, s[44:47], s42 offen nt
  s_barrier
  s_mov_b64 exec, 1
  ds_add_u32 v1, v2 offset:52
  s_mov_b64 exec, -1
  s_mov_b32 s4, s38
  s_mov_b32 s5, s39
  s_mov_b32 s6, 5459968
  s_mov_b32 s7, 0x20000
  s_lshl_b32 s40, s40, 1
  v_lshlrev_b32 v112, 4, v5
  v_add_u32 v112, s40, v112
  v_lshlrev_b32 v113, 4, v4
  s_lshl_b32 s40, s3, 8
  v_add_u32 v113, s40, v113
  s_branch L_A_q
L_LN:
  s_mov_b32 s4, s38
  s_mov_b32 s5, s39
  s_mov_b32 s6, 5459968
  s_mov_b32 s7, 0x20000
  v_add_u32 v6, 12288, v6
  s_waitcnt vmcnt(0)
  v_lshlrev_b32 v32, 16, v8
  v_and_b32 v33, 0xffff0000, v8
  v_lshlrev_b32 v34, 16, v9
  v_and_b32 v35, 0xffff0000, v9
  v_lshlrev_b32 v36, 16, v10
  v_and_b32 v37, 0xffff0000, v10
  v_lshlrev_b32 v38, 16, v11
  v_and_b32 v39, 0xffff0000, v11
  v_lshlrev_b32 v40, 16, v12
  v_and_b32 v41, 0xffff0000, v12
  v_pk_add_f32 v[14:15], v[32:33], v[34:35]
  v_pk_add_f32 v[16:17], v[36:37], v[38:39]
  v_pk_add_f32 v[14:15], v[14:15], v[40:41]
  v_pk_add_f32 v[14:15], v[14:15], v[16:17]
  v_add_f32 v14, v14, v15
  s_nop 1
  v_add_f32_dpp v14, v14, v14 quad_perm:[1,0,3,2] row_mask:0xf bank_mask:0xf
  s_nop 1
  v_add_f32_dpp v14, v14, v14 quad_perm:[2,3,0,1] row_mask:0xf bank_mask:0xf
  s_nop 1
  v_add_f32_dpp v14, v14, v14 row_half_mirror row_mask:0xf bank_mask:0xf
  s_nop 1
  v_add_f32_dpp v14, v14, v14 row_mirror row_mask:0xf bank_mask:0xf
  s_nop 1
  v_add_f32_dpp v14, v14, v14 row_bcast:15 row_mask:0xa bank_mask:0xf
  s_nop 1
  v_add_f32_dpp v14, v14, v14 row_bcast:31 row_mask:0xc bank_mask:0xf
  s_nop 1
  v_readlane_b32 s40, v14, 63
  s_nop 1
  v_mov_b32 v18, 0xbacccccd
  v_mul_f32 v18, s40, v18
  v_mov_b32 v19, v18
  v_pk_add_f32 v[44:45], v[32:33], v[18:19]
  v_pk_add_f32 v[46:47], v[34:35], v[18:19]
  v_pk_add_f32 v[48:49], v[36:37], v[18:19]
  v_pk_add_f32 v[50:51], v[38:39], v[18:19]
  v_pk_add_f32 v[52:53], v[40:41], v[18:19]
  v_pk_mul_f32 v[14:15], v[44:45], v[44:45]
  v_pk_fma_f32 v[14:15], v[46:47], v[46:47], v[14:15]
  v_pk_fma_f32 v[14:15], v[48:49], v[48:49], v[14:15]
  v_pk_fma_f32 v[14:15], v[50:51], v[50:51], v[14:15]
  v_pk_fma_f32 v[14:15], v[52:53], v[52:53], v[14:15]
  v_cvt_pk_bf16_f32 v20, v18, v18
  v_add_f32 v14, v14, v15
  v_and_b32 v20, 0xffff0000, v20
  v_mov_b32 v21, v20
  v_add_f32_dpp v14, v14, v14 quad_perm:[1,0,3,2] row_mask:0xf bank_mask:0xf
  v_pk_add_f32 v[44:45], v[32:33], v[20:21]
  v_pk_add_f32 v[46:47], v[34:35], v[20:21]
  v_add_f32_dpp v14, v14, v14 quad_perm:[2,3,0,1] row_mask:0xf bank_mask:0xf
  v_pk_add_f32 v[48:49], v[36:37], v[20:21]
  v_pk_add_f32 v[50:51], v[38:39], v[20:21]
  v_add_f32_dpp v14, v14, v14 row_half_mirror row_mask:0xf bank_mask:0xf
  v_pk_add_f32 v[52:53], v[40:41], v[20:21]
  v_cvt_pk_bf16_f32 v8, v44, v45
  v_add_f32_dpp v14, v14, v14 row_mirror row_mask:0xf bank_mask:0xf
  v_cvt_pk_bf16_f32 v9, v46, v47
  v_cvt_pk_bf16_f32 v10, v48, v49
  v_add_f32_dpp v14, v14, v14 row_bcast:15 row_mask:0xa bank_mask:0xf
  v_cvt_pk_bf16_f32 v11, v50, v51
  v_cvt_pk_bf16_f32 v12, v52, v53
  v_add_f32_dpp v14, v14, v14 row_bcast:31 row_mask:0xc bank_mask:0xf
  v_lshlrev_b32 v56, 16, v8
  v_and_b32 v57, 0xffff0000, v8
  v_readlane_b32 s42, v14, 63
  v_lshlrev_b32 v58, 16, v9
  v_and_b32 v59, 0xffff0000, v9
  v_mov_b32 v22, 0x3acccccd
  v_mul_f32 v22, s42, v22
  v_cvt_pk_bf16_f32 v22, v22, v22
  v_and_b32 v22, 0xffff0000, v22
  v_add_f32 v22, 0x3727c5ac, v22
  v_cvt_pk_bf16_f32 v22, v22, v22
  v_and_b32 v22, 0xffff0000, v22
  v_sqrt_f32 v22, v22
  v_lshlrev_b32 v60, 16, v10
  v_cvt_pk_bf16_f32 v22, v22, v22
  v_and_b32 v22, 0xffff0000, v22
  v_rcp_f32 v22, v22
  v_and_b32 v61, 0xffff0000, v10
  v_lshlrev_b32 v62, 16, v11
  v_and_b32 v63, 0xffff0000, v11
  v_lshlrev_b32 v64, 16, v12
  v_and_b32 v65, 0xffff0000, v12
  v_mov_b32 v23, v22
  v_pk_mul_f32 v[56:57], v[56:57], v[22:23]
  v_pk_mul_f32 v[58:59], v[58:59], v[22:23]
  v_pk_mul_f32 v[60:61], v[60:61], v[22:23]
  v_pk_mul_f32 v[62:63], v[62:63], v[22:23]
  v_pk_mul_f32 v[64:65], v[64:65], v[22:23]
  v_cvt_pk_bf16_f32 v8, v56, v57
  v_cvt_pk_bf16_f32 v9, v58, v59
  v_cvt_pk_bf16_f32 v10, v60, v61
  v_cvt_pk_bf16_f32 v11, v62, v63
  v_cvt_pk_bf16_f32 v12, v64, v65
  ds_write2_b32 v6, v8, v9 offset0:0 offset1:1
  ds_write2_b32 v6, v10, v11 offset0:2 offset1:3
  ds_write_b32 v6, v12 offset:16
  ds_write_b32 v1, v2 offset:204
  s_branch L_A_q
L_OTH:
  v_lshlrev_b32 v152, 4, v4
  v_lshl_add_u32 v152, v5, 11, v152
  s_cmp_eq_u32 s3, 6
  s_cbranch_scc0 L_noinit
  v_lshlrev_b32 v8, 2, v0
  ds_write_b32 v8, v1
  s_waitcnt lgkmcnt(0)
  L_noinit:
  s_cmp_eq_u32 s3, 9
  s_cbranch_scc1 L_G9
  s_barrier
  s_cmp_eq_u32 s3, 6
  s_cbranch_scc1 L_FFN
  s_cmp_lt_u32 s3, 8
  s_cbranch_scc0 L_OTH2
  s_waitcnt lgkmcnt(0)
  s_mov_b32 s4, s38
  s_mov_b32 s5, s39
  s_mov_b32 s6, 5459968
  s_mov_b32 s7, 0x20000
  s_branch L_A_q
L_OTH2:
  s_cmp_eq_u32 s3, 9
  s_cbranch_scc1 L_G9
  s_cmp_eq_u32 s3, 11
  s_cbranch_scc1 L_FFN
  v_lshrrev_b32 v32, 3, v0
  v_lshrrev_b32 v34, 1, v32
  v_xor_b32 v33, v34, v32
  v_and_b32 v33, 4, v33
  v_and_or_b32 v33, v32, 2, v33
  v_bfe_u32 v34, v32, 3, 1
  v_or_b32 v33, v33, v34
  v_and_b32 v34, 7, v0
  v_xor_b32 v33, v33, v34
  v_lshlrev_b32 v33, 4, v33
  v_lshl_add_u32 v36, v32, 10, v33
  s_bfe_u32 s43, s3, 0x10001
  s_and_b32 s40, s43, 1
  s_mul_i32 s40, s40, 80
  v_xor_b32 v36, s40, v36
  s_lshr_b32 s41, s13, 1
  s_lshl_b32 s42, s12, 4
  s_add_u32 s41, s41, s42
  s_mul_i32 s51, s41, 5
  s_add_u32 s51, s51, s43
  s_lshl_b32 s51, s51, 13
  s_and_b32 s51, s51, 0x1ffff
  s_lshl_b32 s52, s41, 17
  s_add_u32 s41, s52, s51
  s_lshl_b32 s42, s43, 10
  s_add_u32 s42, s42, 30720
  s_waitcnt lgkmcnt(0)
  s_mov_b32 s44, s18
  s_mov_b32 s45, s19
  s_mov_b32 s46, 16777216
  s_mov_b32 s47, 0x20000
  s_mov_b32 s4, s38
  s_mov_b32 s5, s39
  s_mov_b32 s6, 5459968
  s_mov_b32 s7, 0x20000
  s_mov_b32 s29, 65536
  s_branch L_wf_3
L_w_1:
  s_sleep 1
L_wf_3:
  ds_read_b32 v3, v1 offset:0
  s_waitcnt lgkmcnt(0)
  v_readfirstlane_b32 s40, v3
  s_sub_u32 s29, s29, 1
  s_cbranch_scc1 L_wo_2
  s_cmp_ge_u32 s40, 2
  s_cbranch_scc0 L_w_1
L_wo_2:
  s_lshl_b32 s48, s43, 2
  v_mov_b32 v37, s48
  s_mov_b32 s43, 0
L_ld:
  s_add_u32 m0, s42, 0
  s_waitcnt vmcnt(15)
  buffer_load_dwordx4 v36, s[44:47], s41 offen offset:0 nt lds
  s_add_u32 m0, s42, 16256
  s_waitcnt vmcnt(15)
  buffer_load_dwordx4 v36, s[44:47], s41 offen offset:128 nt lds
  s_add_u32 m0, s42, 32512
  s_waitcnt vmcnt(15)
  buffer_load_dwordx4 v36, s[44:47], s41 offen offset:256 nt lds
  s_add_u32 m0, s42, 48768
  s_waitcnt vmcnt(15)
  buffer_load_dwordx4 v36, s[44:47], s41 offen offset:384 nt lds
  s_add_u32 m0, s42, 65024
  s_waitcnt vmcnt(15)
  buffer_load_dwordx4 v36, s[44:47], s41 offen offset:512 nt lds
  s_add_u32 m0, s42, 81280
  s_waitcnt vmcnt(15)
  buffer_load_dwordx4 v36, s[44:47], s41 offen offset:640 nt lds
  s_add_u32 m0, s42, 97536
  s_waitcnt vmcnt(15)
  buffer_load_dwordx4 v36, s[44:47], s41 offen offset:768 nt lds
  s_add_u32 m0, s42, 113792
  s_waitcnt vmcnt(15)
  buffer_load_dwordx4 v36, s[44:47], s41 offen offset:896 nt lds
  s_add_u32 m0, s42, 2048
  s_add_u32 s51, s51, 16384
  s_and_b32 s51, s51, 0x1ffff
  s_add_u32 s41, s52, s51
  s_waitcnt vmcnt(15)
  buffer_load_dwordx4 v36, s[44:47], s41 offen offset:0 nt lds
  s_add_u32 m0, s42, 18304
  s_waitcnt vmcnt(15)
  buffer_load_dwordx4 v36, s[44:47], s41 offen offset:128 nt lds
  s_add_u32 m0, s42, 34560
  s_waitcnt vmcnt(15)
  buffer_load_dwordx4 v36, s[44:47], s41 offen offset:256 nt lds
  s_add_u32 m0, s42, 50816
  s_waitcnt vmcnt(15)
  buffer_load_dwordx4 v36, s[44:47], s41 offen offset:384 nt lds
  s_add_u32 m0, s42, 67072
  s_waitcnt vmcnt(15)
  buffer_load_dwordx4 v36, s[44:47], s41 offen offset:512 nt lds
  s_add_u32 m0, s42, 83328
  s_waitcnt vmcnt(15)
  buffer_load_dwordx4 v36, s[44:47], s41 offen offset:640 nt lds
  s_add_u32 m0, s42, 99584
  s_waitcnt vmcnt(15)
  buffer_load_dwordx4 v36, s[44:47], s41 offen offset:768 nt lds
  s_add_u32 m0, s42, 115840
  s_waitcnt vmcnt(15)
  s_sub_u32 s48, s43, 0
  s_max_i32 s48, s48, 0
  v_mov_b32 v38, s48
  ds_write_b32 v37, v38 offset:224
  buffer_load_dwordx4 v36, s[44:47], s41 offen offset:896 nt lds
  s_add_u32 s51, s51, 16384
  s_and_b32 s51, s51, 0x1ffff
  s_add_u32 s41, s52, s51
  s_add_u32 s42, s42, 4096
  s_add_u32 s43, s43, 1
  s_cmp_lt_u32 s43, 4
  s_cbranch_scc1 L_ld
  s_mov_b64 exec, 1
  ds_add_u32 v1, v2 offset:12
  s_mov_b64 exec, -1
  v_mov_b32 v38, 3
  v_mov_b32 v39, 4
  s_waitcnt vmcnt(16)
  ds_write_b32 v37, v38 offset:224
  s_waitcnt vmcnt(0)
  ds_write_b32 v37, v39 offset:224
  s_branch L_G
L_FFN:
  s_waitcnt lgkmcnt(0)
  s_mov_b32 s4, s38
  s_mov_b32 s5, s39
  s_mov_b32 s6, 5459968
  s_mov_b32 s7, 0x20000
  s_cmp_eq_u32 s3, 11
  s_cbranch_scc1 L_FFNa
  s_mov_b32 s8, s22
  s_mov_b32 s9, s23
  s_mov_b32 s10, 4194304
  s_mov_b32 s11, 0x20000
  v_xor_b32 v8, v4, v5
  v_lshlrev_b32 v8, 4, v8
  v_lshl_add_u32 v8, v5, 13, v8
  v_xor_b32 v9, 64, v8
  v_xor_b32 v10, 128, v8
  v_xor_b32 v11, 192, v8
  s_lshl_b32 s48, s15, 19
  s_lshl_b32 s49, s14, 8
  s_add_u32 s48, s48, s49
  s_mov_b32 s29, 65536
L_w_4:
  ds_read_b32 v3, v1 offset:52
  s_waitcnt lgkmcnt(0)
  v_readfirstlane_b32 s40, v3
  s_sub_u32 s29, s29, 1
  s_cbranch_scc1 L_wo_5
  s_cmp_ge_u32 s40, 5
  s_cbranch_scc0 L_w_4
L_wo_5:
  s_mov_b32 m0, 14336
  s_add_u32 s49, s48, 0
  buffer_load_dwordx4 v8, s[8:11], s49 offen nt lds
  s_mov_b32 m0, 15360
  s_add_u32 s49, s48, 32768
  buffer_load_dwordx4 v9, s[8:11], s49 offen nt lds
  s_mov_b32 m0, 16384
  s_add_u32 s49, s48, 65536
  buffer_load_dwordx4 v10, s[8:11], s49 offen nt lds
  s_mov_b32 m0, 17408
  s_add_u32 s49, s48, 98304
  buffer_load_dwordx4 v11, s[8:11], s49 offen nt lds
  s_mov_b32 m0, 18432
  s_add_u32 s49, s48, 131072
  buffer_load_dwordx4 v8, s[8:11], s49 offen nt lds
  s_mov_b32 m0, 19456
  s_add_u32 s49, s48, 163840
  buffer_load_dwordx4 v9, s[8:11], s49 offen nt lds
  s_mov_b32 m0, 20480
  s_add_u32 s49, s48, 196608
  buffer_load_dwordx4 v10, s[8:11], s49 offen nt lds
  s_mov_b32 m0, 21504
  s_add_u32 s49, s48, 229376
  buffer_load_dwordx4 v11, s[8:11], s49 offen nt lds
  s_mov_b32 m0, 22528
  s_add_u32 s49, s48, 262144
  buffer_load_dwordx4 v8, s[8:11], s49 offen nt lds
  s_mov_b32 m0, 23552
  s_add_u32 s49, s48, 294912
  buffer_load_dwordx4 v9, s[8:11], s49 offen nt lds
  s_mov_b32 m0, 24576
  s_add_u32 s49, s48, 327680
  buffer_load_dwordx4 v10, s[8:11], s49 offen nt lds
  s_mov_b32 m0, 25600
  s_add_u32 s49, s48, 360448
  buffer_load_dwordx4 v11, s[8:11], s49 offen nt lds
  s_mov_b32 m0, 26624
  s_add_u32 s49, s48, 393216
  buffer_load_dwordx4 v8, s[8:11], s49 offen nt lds
  s_mov_b32 m0, 27648
  s_add_u32 s49, s48, 425984
  buffer_load_dwordx4 v9, s[8:11], s49 offen nt lds
  s_mov_b32 m0, 28672
  s_add_u32 s49, s48, 458752
  buffer_load_dwordx4 v10, s[8:11], s49 offen nt lds
  s_mov_b32 m0, 29696
  s_add_u32 s49, s48, 491520
  buffer_load_dwordx4 v11, s[8:11], s49 offen nt lds
  s_branch L_A_q
L_FFNa:
  s_mov_b32 s29, 65536
  s_branch L_wf_8
L_w_6:
  s_sleep 1
L_wf_8:
  ds_read_b32 v3, v1 offset:0
  s_waitcnt lgkmcnt(0)
  v_readfirstlane_b32 s40, v3
  s_sub_u32 s29, s29, 1
  s_cbranch_scc1 L_wo_7
  s_cmp_ge_u32 s40, 2
  s_cbranch_scc0 L_w_6
L_wo_7:
  s_branch L_FFNb
L_G9:
  s_setprio 3
  s_waitcnt lgkmcnt(0)
  s_load_dword s40, s[38:39], 0
  s_barrier
  s_mov_b32 s4, s38
  s_mov_b32 s5, s39
  s_mov_b32 s6, 5459968
  s_mov_b32 s7, 0x20000
  v_lshlrev_b32 v8, 4, v4
  s_lshl_b32 s41, s14, 3
  s_add_u32 s41, s41, s15
  s_lshl_b32 s41, s41, 8
  s_add_u32 s43, s41, 593920
  s_lshl_b32 s42, s14, 14
  s_lshl_b32 s41, s15, 8
  s_add_u32 s42, s42, s41
  s_add_u32 s42, s42, 4096
  s_add_u32 s45, s42, 8192
  v_lshl_add_u32 v7, v5, 11, v8
  v_mov_b32 v11, 1
  s_waitcnt lgkmcnt(0)
  s_mul_i32 s28, s40, 1664525
  s_add_u32 s28, s28, 1013904223
  v_mov_b32 v10, s28
  v_mov_b32 v13, s28
  v_mov_b32 v15, s28
  ds_write_b64 v1, v[10:11] offset:40
  s_and_b32 s46, s13, 1
  s_lshl_b32 s46, s46, 7
  s_add_u32 s46, s46, s12
  s_lshl_b32 s46, s46, 7
  s_add_u32 s46, s46, 528384
  v_lshlrev_b32 v9, 10, v4
  v_and_b32 v16, 0, v5
  v_lshl_add_u32 v9, v16, 15, v9
  s_add_u32 s46, s46, 32768
  s_mov_b32 s29, 65536
L_w_9:
  ds_read_b32 v3, v1 offset:52
  s_waitcnt lgkmcnt(0)
  v_readfirstlane_b32 s40, v3
  s_sub_u32 s29, s29, 1
  s_cbranch_scc1 L_wo_10
  s_cmp_ge_u32 s40, 5
  s_cbranch_scc0 L_w_9
L_wo_10:
  buffer_load_dwordx4 v[16:19], v7, s[4:7], s42 offen sc1
  s_mov_b64 exec, -1
  buffer_load_dwordx4 v[16:19], v7, s[4:7], s45 offen sc1
  buffer_load_dwordx4 v[16:19], v8, s[4:7], s43 offen sc1
  buffer_load_dword v16, v9, s[4:7], s46 offen sc1
  s_mov_b32 s29, 65536
L_w_11:
  ds_read_b32 v3, v1 offset:0
  ds_read_b128 v[32:35], v8 offset:256
  ds_read_b128 v[36:39], v8 offset:512
  ds_read_b128 v[40:43], v8 offset:768
  ds_read_b128 v[44:47], v8 offset:1024
  ds_read_b128 v[48:51], v8 offset:1280
  s_waitcnt lgkmcnt(0)
  v_readfirstlane_b32 s40, v3
  s_sub_u32 s29, s29, 1
  s_cbranch_scc1 L_wo_12
  s_cmp_ge_u32 s40, 5
  s_cbranch_scc0 L_w_11
L_wo_12:
  v_pk_add_f32 v[32:33], v[32:33], v[36:37]
  v_pk_add_f32 v[34:35], v[34:35], v[38:39]
  v_pk_add_f32 v[40:41], v[40:41], v[44:45]
  v_pk_add_f32 v[42:43], v[42:43], v[46:47]
  v_pk_add_f32 v[32:33], v[32:33], v[40:41]
  v_pk_add_f32 v[34:35], v[34:35], v[42:43]
  v_pk_add_f32 v[32:33], v[32:33], v[48:49]
  v_pk_add_f32 v[34:35], v[34:35], v[50:51]
  v_cvt_pk_bf16_f32 v12, v32, v33
  v_cvt_pk_bf16_f32 v14, v34, v35
  buffer_store_dwordx4 v[12:15], v7, s[4:7], s42 offen
  ds_write_b32 v1, v2 offset:48
  buffer_store_dwordx4 v[12:15], v7, s[4:7], s45 offen
  v_mov_b32 v148, v12
  v_mov_b32 v149, v13
  v_mov_b32 v150, v14
  v_mov_b32 v151, v15
  s_mov_b32 s70, s42
  s_mov_b32 s71, s45
  s_mov_b64 exec, 0xffff
  s_mov_b32 s29, 65536
L_w_13:
  s_cmp_lg_u32 s29, 65472
  s_cbranch_scc1 L_wd_15
  buffer_store_dwordx4 v[148:151], v152, s[4:7], s70 offen sc1
  L_wd_15:
  ds_read_b32 v3, v1 offset:4
  s_waitcnt lgkmcnt(0)
  v_readfirstlane_b32 s40, v3
  s_sub_u32 s29, s29, 1
  s_cbranch_scc1 L_wo_14
  s_cmp_ge_u32 s40, 6
  s_cbranch_scc0 L_w_13
L_wo_14:
  s_mov_b32 s29, 65536
L_w_16:
  s_cmp_lg_u32 s29, 65472
  s_cbranch_scc1 L_wd_18
  buffer_store_dwordx4 v[148:151], v152, s[4:7], s70 offen sc1
  L_wd_18:
  ds_read_b32 v3, v1 offset:4
  ds_read_b128 v[32:35], v8 offset:1536
  ds_read_b128 v[36:39], v8 offset:1792
  ds_read_b128 v[40:43], v8 offset:2048
  ds_read_b128 v[44:47], v8 offset:2304
  ds_read_b128 v[48:51], v8 offset:2560
  ds_read_b128 v[52:55], v8 offset:2816
  ds_read_b128 v[56:59], v8 offset:3072
  ds_read_b128 v[60:63], v8 offset:3328
  s_waitcnt lgkmcnt(0)
  v_readfirstlane_b32 s40, v3
  s_sub_u32 s29, s29, 1
  s_cbranch_scc1 L_wo_17
  s_cmp_ge_u32 s40, 8
  s_cbranch_scc0 L_w_16
L_wo_17:
  v_pk_add_f32 v[32:33], v[32:33], v[36:37]
  v_pk_add_f32 v[34:35], v[34:35], v[38:39]
  v_pk_add_f32 v[40:41], v[40:41], v[44:45]
  v_pk_add_f32 v[42:43], v[42:43], v[46:47]
  v_pk_add_f32 v[48:49], v[48:49], v[52:53]
  v_pk_add_f32 v[50:51], v[50:51], v[54:55]
  v_pk_add_f32 v[56:57], v[56:57], v[60:61]
  v_pk_add_f32 v[58:59], v[58:59], v[62:63]
  v_pk_add_f32 v[32:33], v[32:33], v[40:41]
  v_pk_add_f32 v[34:35], v[34:35], v[42:43]
  v_pk_add_f32 v[48:49], v[48:49], v[56:57]
  v_pk_add_f32 v[50:51], v[50:51], v[58:59]
  v_pk_add_f32 v[32:33], v[32:33], v[48:49]
  v_pk_add_f32 v[34:35], v[34:35], v[50:51]
  v_mul_f32 v32, 0x3e0293ee, v32
  v_mul_f32 v33, 0x3e0293ee, v33
  v_mul_f32 v34, 0x3e0293ee, v34
  v_mul_f32 v35, 0x3e0293ee, v35
  v_cvt_pk_bf16_f32 v12, v32, v33
  v_cvt_pk_bf16_f32 v14, v34, v35
  buffer_store_dwordx4 v[12:15], v8, s[4:7], s43 offen sc1
  ds_write_b32 v1, v2 offset:200
  s_mov_b64 exec, -1
  s_setprio 0
  s_mov_b32 s29, 65536
  s_branch L_wf_21
L_w_19:
  s_sleep 1
L_wf_21:
  ds_read_b32 v3, v1 offset:12
  s_waitcnt lgkmcnt(0)
  v_readfirstlane_b32 s40, v3
  s_sub_u32 s29, s29, 1
  s_cbranch_scc1 L_wo_20
  s_cmp_ge_u32 s40, 2
  s_cbranch_scc0 L_w_19
L_wo_20:
  s_branch L_G_uv9
L_A_q:
  s_setprio 2
  s_and_b32 s40, s13, 1
  s_lshl_b32 s41, s40, 4
  s_lshl_b32 s42, s3, 1
  s_add_u32 s41, s41, s42
  s_lshl_b32 s41, s41, 11
  s_add_u32 s20, s41, 593920
  s_lshr_b32 s21, s13, 1
  s_lshl_b32 s42, s40, 7
  s_add_u32 s42, s42, s3
  s_lshl_b32 s42, s42, 3
  s_add_u32 s42, s42, s12
  s_lshl_b32 s42, s42, 4
  s_add_u32 s42, s42, s21
  s_lshl_b32 s42, s42, 7
  s_add_u32 s26, s42, 1265664
  s_add_u32 s22, s26, 262144
  s_lshl_b32 s42, s40, 7
  s_add_u32 s42, s42, s12
  s_lshl_b32 s42, s42, 4
  s_add_u32 s42, s42, s21
  s_lshl_b32 s42, s42, 3
  s_add_u32 s27, s42, 528384
  s_add_u32 s23, s27, 32768
  s_lshl_b32 s42, s14, 3
  s_add_u32 s42, s42, s3
  s_lshl_b32 s42, s42, 7
  s_add_u32 s31, s42, 528384
  s_lshl_b32 s42, s14, 3
  s_add_u32 s42, s42, s15
  s_lshl_b32 s42, s42, 3
  s_add_u32 s42, s42, s3
  s_lshl_b32 s30, s42, 11
  s_add_u32 s30, s30, 1265664
  s_lshl_b32 s42, s14, 3
  s_and_b32 s43, s15, 0
  s_add_u32 s42, s42, s43
  s_lshl_b32 s42, s42, 3
  s_add_u32 s42, s42, s3
  s_lshl_b32 s42, s42, 8
  s_add_u32 s42, s42, 4096
  s_add_u32 s32, s4, s42
  s_addc_u32 s33, s5, 0
  s_mov_b32 s25, s42
  s_and_b32 s40, s3, 1
  s_lshl_b32 s40, s40, 3
  v_xor_b32 v6, s40, v4
  v_lshlrev_b32 v6, 4, v6
  v_lshl_add_u32 v6, v0, 8, v6
  v_lshlrev_b32 v10, 2, v0
  s_lshl_b32 s40, s3, 8
  v_add_u32 v10, s40, v10
  v_mov_b32 v8, 0
  v_mov_b32 v9, 0
  v_lshrrev_b32 v25, 1, v4
  v_xor_b32 v24, v25, v4
  v_and_b32 v24, 4, v24
  v_and_or_b32 v24, v4, 2, v24
  v_bfe_u32 v25, v4, 3, 1
  v_or_b32 v24, v24, v25
  v_xor_b32 v24, v24, v5
  v_lshlrev_b32 v24, 4, v24
  v_and_b32 v25, 7, v4
  v_lshl_add_u32 v24, v25, 7, v24
  v_lshrrev_b32 v25, 3, v4
  v_lshl_add_u32 v24, v25, 10, v24
  s_lshl_b32 s42, s3, 11
  s_add_u32 s42, s42, 30720
  v_add_u32 v160, s42, v24
  v_xor_b32 v161, 64, v160
  v_add_u32 v162, 0x10000, v160
  v_add_u32 v163, 0x10000, v161
  v_lshrrev_b32 v26, 2, v0
  v_lshrrev_b32 v25, 1, v26
  v_xor_b32 v24, v25, v26
  v_and_b32 v24, 4, v24
  v_and_or_b32 v24, v26, 2, v24
  v_bfe_u32 v25, v26, 3, 1
  v_or_b32 v24, v24, v25
  s_and_b32 s42, s3, 3
  s_lshl_b32 s42, s42, 1
  v_bfe_u32 v25, v0, 1, 1
  v_or_b32 v25, s42, v25
  v_xor_b32 v24, v24, v25
  v_lshlrev_b32 v24, 4, v24
  v_and_b32 v25, 1, v0
  v_lshl_add_u32 v24, v25, 3, v24
  v_and_b32 v25, 7, v26
  v_lshl_add_u32 v24, v25, 7, v24
  v_lshrrev_b32 v25, 3, v26
  v_lshl_add_u32 v24, v25, 10, v24
  s_lshr_b32 s42, s3, 2
  s_lshl_b32 s42, s42, 14
  s_add_u32 s42, s42, 30720
  v_add_u32 v164, s42, v24
  v_add_u32 v165, 0x10000, v164
  v_lshrrev_b32 v24, 1, v4
  v_and_b32 v25, 4, v24
  v_lshl_or_b32 v25, v25, 1, v24
  s_lshl_b32 s42, s3, 1
  v_xor_b32 v25, s42, v25
  v_lshlrev_b32 v25, 4, v25
  v_lshl_add_u32 v25, v24, 8, v25
  v_lshl_add_u32 v25, v5, 11, v25
  v_and_b32 v24, 1, v0
  v_lshl_add_u32 v28, v24, 3, v25
  v_xor_b32 v29, 16, v28
  v_xor_b32 v30, v4, v5
  v_lshlrev_b32 v30, 4, v30
  v_lshl_add_u32 v30, v5, 8, v30
  v_xor_b32 v31, 192, v30
  v_lshlrev_b32 v166, 4, v0
  s_cmp_ge_u32 s3, 5
  s_cbranch_scc1 L_A_q2
  s_waitcnt vmcnt(6)
  v_perm_b32 v48, v34, v32, s100
  v_perm_b32 v52, v34, v32, s101
  v_perm_b32 v56, v35, v33, s100
  v_perm_b32 v60, v35, v33, s101
  s_waitcnt vmcnt(4)
  v_perm_b32 v49, v38, v36, s100
  v_perm_b32 v53, v38, v36, s101
  v_perm_b32 v57, v39, v37, s100
  v_perm_b32 v61, v39, v37, s101
  s_waitcnt vmcnt(2)
  v_perm_b32 v50, v42, v40, s100
  v_perm_b32 v54, v42, v40, s101
  v_perm_b32 v58, v43, v41, s100
  v_perm_b32 v62, v43, v41, s101
  s_waitcnt vmcnt(0)
  v_perm_b32 v51, v46, v44, s100
  v_perm_b32 v55, v46, v44, s101
  v_perm_b32 v59, v47, v45, s100
  v_perm_b32 v63, v47, v45, s101
  s_mov_b32 s29, 65536
L_w_22:
  ds_read_b32 v3, v1 offset:204
  ds_read_b128 v[116:119], v112 offset:12288
  s_waitcnt lgkmcnt(0)
  v_readfirstlane_b32 s19, v3
  s_sub_u32 s29, s29, 1
  s_cbranch_scc1 L_wo_23
  s_cmp_ge_u32 s19, 1
  s_cbranch_scc0 L_w_22
L_wo_23:
  v_mfma_f32_16x16x32_bf16 v[64:67], v[116:119], v[48:51], 0
  v_mfma_f32_16x16x32_bf16 v[68:71], v[116:119], v[52:55], 0
  v_mfma_f32_16x16x32_bf16 v[72:75], v[116:119], v[56:59], 0
  v_mfma_f32_16x16x32_bf16 v[76:79], v[116:119], v[60:63], 0
  s_nop 6
  v_mov_b32 v65, v68
  v_mov_b32 v66, v72
  v_mov_b32 v67, v76
  s_mov_b64 exec, 0xffff
  ds_write_b128 v113, v[64:67] offset:256
  s_mov_b64 exec, 1
  ds_add_u32 v1, v2 offset:0
  s_mov_b64 exec, -1
L_A_q2:
  s_mov_b32 s29, 65536
L_w_24:
  ds_read_b32 v3, v1 offset:44
  ds_read_b32 v7, v1 offset:40
  s_waitcnt lgkmcnt(0)
  v_readfirstlane_b32 s28, v3
  s_sub_u32 s29, s29, 1
  s_cbranch_scc1 L_wo_25
  s_cmp_ge_u32 s28, 1
  s_cbranch_scc0 L_w_24
L_wo_25:
  v_readfirstlane_b32 s28, v7
  s_lshl_b32 s18, s28, 5
  s_cmp_eq_u32 s3, 6
  s_cbranch_scc0 L_nouk
  s_waitcnt vmcnt(0)
  ds_write_b32 v1, v2 offset:36
L_nouk:
  s_mov_b32 s29, 65536
  s_branch L_wf_28
L_w_26:
  s_sleep 1
L_wf_28:
  ds_read_b32 v3, v1 offset:48
  s_waitcnt lgkmcnt(0)
  v_readfirstlane_b32 s19, v3
  s_sub_u32 s29, s29, 1
  s_cbranch_scc1 L_wo_27
  s_cmp_ge_u32 s19, 1
  s_cbranch_scc0 L_w_26
L_wo_27:
  s_sleep 8
  ds_read_b32 v3, v1 offset:36
  s_waitcnt lgkmcnt(0)
  v_readfirstlane_b32 s24, v3
  s_nop 0
  s_cmp_eq_u32 s24, 0
  s_cbranch_scc1 L_now
  ds_read_b128 v[80:83], v6 offset:14336
  v_xor_b32 v7, 16, v6
  ds_read_b128 v[84:87], v7 offset:14336
  v_xor_b32 v7, 32, v6
  ds_read_b128 v[88:91], v7 offset:14336
  v_xor_b32 v7, 48, v6
  ds_read_b128 v[92:95], v7 offset:14336
  v_xor_b32 v7, 64, v6
  ds_read_b128 v[96:99], v7 offset:14336
  v_xor_b32 v7, 80, v6
  ds_read_b128 v[100:103], v7 offset:14336
  v_xor_b32 v7, 96, v6
  ds_read_b128 v[104:107], v7 offset:14336
  v_xor_b32 v7, 112, v6
  ds_read_b128 v[108:111], v7 offset:14336
L_now:
  s_mov_b32 s29, 8192
  s_branch L_h1f_31
L_h1_29:
  s_cmp_le_u32 s29, 8184
  s_cbranch_scc1 L_h1v_32
  s_sleep 1
  s_cmp_gt_u32 s29, 8188
  s_cbranch_scc1 L_h1b_33
  s_sleep 6
  L_h1b_33:
L_h1f_31:
  s_load_dwordx16 s[36:51], s[32:33], 0
  s_load_dwordx16 s[52:67], s[32:33], 64
  s_load_dwordx16 s[68:83], s[32:33], 128
  s_load_dwordx16 s[84:99], s[32:33], 192
  s_add_u32 s32, s32, 2048
  s_addc_u32 s33, s33, 0
  s_sub_u32 s29, s29, 1
  s_waitcnt lgkmcnt(0)
  s_cmp_eq_u32 s99, s28
  s_cbranch_scc0 L_h1_29
  s_add_u32 s19, s37, s39
  s_add_u32 s19, s19, s41
  s_add_u32 s19, s19, s43
  s_add_u32 s19, s19, s45
  s_add_u32 s19, s19, s47
  s_add_u32 s19, s19, s49
  s_add_u32 s19, s19, s51
  s_add_u32 s19, s19, s53
  s_add_u32 s19, s19, s55
  s_add_u32 s19, s19, s57
  s_add_u32 s19, s19, s59
  s_add_u32 s19, s19, s61
  s_add_u32 s19, s19, s63
  s_add_u32 s19, s19, s65
  s_add_u32 s19, s19, s67
  s_add_u32 s19, s19, s69
  s_add_u32 s19, s19, s71
  s_add_u32 s19, s19, s73
  s_add_u32 s19, s19, s75
  s_add_u32 s19, s19, s77
  s_add_u32 s19, s19, s79
  s_add_u32 s19, s19, s81
  s_add_u32 s19, s19, s83
  s_add_u32 s19, s19, s85
  s_add_u32 s19, s19, s87
  s_add_u32 s19, s19, s89
  s_add_u32 s19, s19, s91
  s_add_u32 s19, s19, s93
  s_add_u32 s19, s19, s95
  s_add_u32 s19, s19, s97
  s_add_u32 s19, s19, s99
  s_cmp_eq_u32 s19, s18
  s_cbranch_scc0 L_h1_29
L_h1o_30:
  s_cmp_eq_u32 s24, 0
  s_cbranch_scc0 L_havew
  s_mov_b32 s29, 65536
L_w_34:
  ds_read_b32 v3, v1 offset:36
  s_waitcnt lgkmcnt(0)
  v_readfirstlane_b32 s19, v3
  s_sub_u32 s29, s29, 1
  s_cbranch_scc1 L_wo_35
  s_cmp_ge_u32 s19, 1
  s_cbranch_scc0 L_w_34
L_wo_35:
  ds_read_b128 v[80:83], v6 offset:14336
  v_xor_b32 v7, 16, v6
  ds_read_b128 v[84:87], v7 offset:14336
  v_xor_b32 v7, 32, v6
  ds_read_b128 v[88:91], v7 offset:14336
  v_xor_b32 v7, 48, v6
  ds_read_b128 v[92:95], v7 offset:14336
  v_xor_b32 v7, 64, v6
  ds_read_b128 v[96:99], v7 offset:14336
  v_xor_b32 v7, 80, v6
  ds_read_b128 v[100:103], v7 offset:14336
  v_xor_b32 v7, 96, v6
  ds_read_b128 v[104:107], v7 offset:14336
  v_xor_b32 v7, 112, v6
  ds_read_b128 v[108:111], v7 offset:14336
L_havew:
  s_waitcnt lgkmcnt(7)
  v_dot2c_f32_bf16 v8, s36, v80
  v_dot2c_f32_bf16 v9, s38, v81
  v_dot2c_f32_bf16 v8, s40, v82
  v_dot2c_f32_bf16 v9, s42, v83
  s_waitcnt lgkmcnt(6)
  v_dot2c_f32_bf16 v8, s44, v84
  v_dot2c_f32_bf16 v9, s46, v85
  v_dot2c_f32_bf16 v8, s48, v86
  v_dot2c_f32_bf16 v9, s50, v87
  s_waitcnt lgkmcnt(5)
  v_dot2c_f32_bf16 v8, s52, v88
  v_dot2c_f32_bf16 v9, s54, v89
  v_dot2c_f32_bf16 v8, s56, v90
  v_dot2c_f32_bf16 v9, s58, v91
  s_waitcnt lgkmcnt(4)
  v_dot2c_f32_bf16 v8, s60, v92
  v_dot2c_f32_bf16 v9, s62, v93
  v_dot2c_f32_bf16 v8, s64, v94
  v_dot2c_f32_bf16 v9, s66, v95
  s_waitcnt lgkmcnt(3)
  v_dot2c_f32_bf16 v8, s68, v96
  v_dot2c_f32_bf16 v9, s70, v97
  v_dot2c_f32_bf16 v8, s72, v98
  v_dot2c_f32_bf16 v9, s74, v99
  s_waitcnt lgkmcnt(2)
  v_dot2c_f32_bf16 v8, s76, v100
  v_dot2c_f32_bf16 v9, s78, v101
  v_dot2c_f32_bf16 v8, s80, v102
  v_dot2c_f32_bf16 v9, s82, v103
  s_waitcnt lgkmcnt(1)
  v_dot2c_f32_bf16 v8, s84, v104
  v_dot2c_f32_bf16 v9, s86, v105
  v_dot2c_f32_bf16 v8, s88, v106
  v_dot2c_f32_bf16 v9, s90, v107
  s_waitcnt lgkmcnt(0)
  v_dot2c_f32_bf16 v8, s92, v108
  v_dot2c_f32_bf16 v9, s94, v109
  v_dot2c_f32_bf16 v8, s96, v110
  v_dot2c_f32_bf16 v9, s98, v111
  s_nop 2
  v_add_f32 v8, v8, v9
  ds_write_b32 v10, v8 offset:1536
  s_mov_b64 exec, 1
  ds_add_u32 v1, v2 offset:4
  s_mov_b64 exec, -1
  s_lshr_b32 s42, s3, 1
  s_lshl_b32 s48, s42, 2
  s_lshl_b32 s48, 1, s48
  s_add_u32 s49, s48, 0x10000
  s_mov_b32 s50, 0x42800000
  s_lshl_b32 s42, s42, 10
  s_and_b32 s43, s3, 1
  s_lshl_b32 s43, s43, 3
  s_add_u32 s42, s42, s43
  v_add_u32 v7, s42, v166
  v_add_u32 v28, 14336, v28
  v_add_u32 v29, 14336, v29
  v_add_u32 v26, 8192, v28
  v_add_u32 v27, 8192, v29
  s_and_b32 s45, s28, 1
  s_mul_i32 s45, s45, 0x55555555
  s_and_b32 s44, s28, 0xaaaaaaaa
  s_or_b32 s45, s45, s44
  s_mov_b32 s44, 0x00010001
  s_mov_b32 s29, 65536
L_w_36:
  ds_read_b32 v3, v1 offset:200
  s_waitcnt lgkmcnt(0)
  v_readfirstlane_b32 s42, v3
  s_sub_u32 s29, s29, 1
  s_cbranch_scc1 L_wo_37
  s_cmp_ge_u32 s42, 1
  s_cbranch_scc0 L_w_36
L_wo_37:
  s_mov_b32 s29, 65536
L_lw_38:
  ds_read_b64 v[24:25], v1 offset:224
  s_waitcnt lgkmcnt(0)
  v_min_u32 v24, v24, v25
  s_sub_u32 s29, s29, 1
  v_readfirstlane_b32 s42, v24
  s_cbranch_scc1 L_lwo_39
  s_cmp_ge_u32 s42, 2
  s_cbranch_scc1 L_lwo_39
  s_sleep 1
  s_branch L_lw_38
L_lwo_39:
  ds_read_b64_tr_b16 v[96:97], v164 offset:0
  ds_read_b64_tr_b16 v[98:99], v164 offset:2048
  ds_read_b64_tr_b16 v[112:113], v164 offset:32768
  ds_read_b64_tr_b16 v[114:115], v164 offset:34816
  ds_read_b64_tr_b16 v[128:129], v165 offset:0
  ds_read_b64_tr_b16 v[130:131], v165 offset:2048
  ds_read_b64_tr_b16 v[144:145], v165 offset:32768
  ds_read_b64_tr_b16 v[146:147], v165 offset:34816
  ds_read_b64_tr_b16 v[100:101], v164 offset:4096
  ds_read_b64_tr_b16 v[102:103], v164 offset:6144
  ds_read_b64_tr_b16 v[116:117], v164 offset:36864
  ds_read_b64_tr_b16 v[118:119], v164 offset:38912
  ds_read_b64_tr_b16 v[132:133], v165 offset:4096
  ds_read_b64_tr_b16 v[134:135], v165 offset:6144
  ds_read_b64_tr_b16 v[148:149], v165 offset:36864
  ds_read_b64_tr_b16 v[150:151], v165 offset:38912
  s_mov_b32 s29, 65536
L_lw_40:
  ds_read_b64 v[24:25], v1 offset:224
  s_waitcnt lgkmcnt(0)
  v_min_u32 v24, v24, v25
  s_sub_u32 s29, s29, 1
  v_readfirstlane_b32 s42, v24
  s_cbranch_scc1 L_lwo_41
  s_cmp_ge_u32 s42, 3
  s_cbranch_scc1 L_lwo_41
  s_sleep 1
  s_branch L_lw_40
L_lwo_41:
  buffer_load_dwordx4 v[8:11], v166, s[4:7], s20 offen offset:0 sc1
  buffer_load_dwordx4 v[12:15], v166, s[4:7], s20 offen offset:1024 sc1
  buffer_load_dwordx4 v[16:19], v166, s[4:7], s20 offen offset:2048 sc1
  buffer_load_dwordx4 v[20:23], v166, s[4:7], s20 offen offset:3072 sc1
  ds_read_b64_tr_b16 v[104:105], v164 offset:8192
  ds_read_b64_tr_b16 v[106:107], v164 offset:10240
  ds_read_b64_tr_b16 v[120:121], v164 offset:40960
  ds_read_b64_tr_b16 v[122:123], v164 offset:43008
  ds_read_b64_tr_b16 v[136:137], v165 offset:8192
  ds_read_b64_tr_b16 v[138:139], v165 offset:10240
  ds_read_b64_tr_b16 v[152:153], v165 offset:40960
  ds_read_b64_tr_b16 v[154:155], v165 offset:43008
  s_cmp_lt_u32 s3, 6
  s_cbranch_scc1 L_qka
  s_mov_b32 s29, 65536
L_lw_42:
  ds_read_b64 v[24:25], v1 offset:224
  s_waitcnt lgkmcnt(0)
  v_min_u32 v24, v24, v25
  s_sub_u32 s29, s29, 1
  v_readfirstlane_b32 s42, v24
  s_cbranch_scc1 L_lwo_43
  s_cmp_ge_u32 s42, 4
  s_cbranch_scc1 L_lwo_43
  s_branch L_lw_42
L_lwo_43:
L_qka:
  ds_read_b128 v[32:35], v160 offset:0
  ds_read_b128 v[36:39], v161 offset:0
  ds_read_b128 v[40:43], v160 offset:16384
  ds_read_b128 v[44:47], v161 offset:16384
  ds_read_b128 v[48:51], v160 offset:32768
  ds_read_b128 v[52:55], v161 offset:32768
  ds_read_b128 v[56:59], v160 offset:49152
  ds_read_b128 v[60:63], v161 offset:49152
  ds_read_b128 v[64:67], v162 offset:0
  ds_read_b128 v[68:71], v163 offset:0
  ds_read_b128 v[72:75], v162 offset:16384
  ds_read_b128 v[76:79], v163 offset:16384
  ds_read_b128 v[80:83], v162 offset:32768
  ds_read_b128 v[84:87], v163 offset:32768
  ds_read_b128 v[88:91], v162 offset:49152
  ds_read_b128 v[92:95], v163 offset:49152
  s_mov_b32 s43, 8192
L_h2c_44:
  s_waitcnt vmcnt(0)
  v_xor_b32 v24, s28, v9
  v_bitop3_b32 v24, v11, s28, v24 bitop3:0xbe
  v_bitop3_b32 v24, v13, s28, v24 bitop3:0xbe
  v_bitop3_b32 v24, v15, s28, v24 bitop3:0xbe
  v_bitop3_b32 v24, v17, s28, v24 bitop3:0xbe
  v_bitop3_b32 v24, v19, s28, v24 bitop3:0xbe
  v_bitop3_b32 v24, v21, s28, v24 bitop3:0xbe
  v_bitop3_b32 v24, v23, s28, v24 bitop3:0xbe
  v_cmp_ne_u32 vcc, 0, v24
  s_cbranch_vccz L_h2co_45
  s_sub_u32 s43, s43, 1
  s_cbranch_scc1 L_h2co_45
  s_sleep 4
  s_mov_b64 exec, vcc
  buffer_load_dwordx4 v[8:11], v166, s[4:7], s20 offen offset:0 sc1
  buffer_load_dwordx4 v[12:15], v166, s[4:7], s20 offen offset:1024 sc1
  buffer_load_dwordx4 v[16:19], v166, s[4:7], s20 offen offset:2048 sc1
  buffer_load_dwordx4 v[20:23], v166, s[4:7], s20 offen offset:3072 sc1
  s_mov_b64 exec, -1
  s_branch L_h2c_44
L_h2co_45:
  ds_write2_b32 v28, v8, v10 offset0:0 offset1:1
  ds_write2_b32 v26, v12, v14 offset0:0 offset1:1
  ds_write2_b32 v29, v16, v18 offset0:0 offset1:1
  ds_write2_b32 v27, v20, v22 offset0:0 offset1:1
  s_mov_b64 exec, 1
  ds_add_u32 v1, v2 offset:20
  s_mov_b64 exec, -1
  s_mov_b32 s29, 65536
L_w_46:
  ds_read_b32 v3, v1 offset:20
  s_waitcnt lgkmcnt(0)
  v_readfirstlane_b32 s42, v3
  s_sub_u32 s29, s29, 1
  s_cbranch_scc1 L_wo_47
  s_cmp_ge_u32 s42, 8
  s_cbranch_scc0 L_w_46
L_wo_47:
  ds_read_b128 v[8:11], v30 offset:14336
  ds_read_b128 v[12:15], v31 offset:15360
  ds_read_b128 v[16:19], v30 offset:16384
  ds_read_b128 v[20:23], v31 offset:17408
  s_waitcnt lgkmcnt(3)
  v_mfma_f32_16x16x32_bf16 v[24:27], v[32:35], v[8:11], 0
  ds_read_b128 v[8:11], v30 offset:18432
  s_waitcnt lgkmcnt(3)
  v_mfma_f32_16x16x32_bf16 v[24:27], v[36:39], v[12:15], v[24:27]
  ds_read_b128 v[12:15], v31 offset:19456
  s_waitcnt lgkmcnt(3)
  v_mfma_f32_16x16x32_bf16 v[24:27], v[40:43], v[16:19], v[24:27]
  ds_read_b128 v[16:19], v30 offset:20480
  s_waitcnt lgkmcnt(3)
  v_mfma_f32_16x16x32_bf16 v[24:27], v[44:47], v[20:23], v[24:27]
  ds_read_b128 v[20:23], v31 offset:21504
  s_waitcnt lgkmcnt(3)
  v_mfma_f32_16x16x32_bf16 v[24:27], v[48:51], v[8:11], v[24:27]
  ds_read_b128 v[8:11], v30 offset:22528
  s_waitcnt lgkmcnt(3)
  v_mfma_f32_16x16x32_bf16 v[24:27], v[52:55], v[12:15], v[24:27]
  ds_read_b128 v[12:15], v31 offset:23552
  s_waitcnt lgkmcnt(3)
  v_mfma_f32_16x16x32_bf16 v[24:27], v[56:59], v[16:19], v[24:27]
  ds_read_b128 v[16:19], v30 offset:24576
  s_waitcnt lgkmcnt(3)
  v_mfma_f32_16x16x32_bf16 v[24:27], v[60:63], v[20:23], v[24:27]
  ds_read_b128 v[20:23], v31 offset:25600
  s_waitcnt lgkmcnt(3)
  v_mfma_f32_16x16x32_bf16 v[24:27], v[64:67], v[8:11], v[24:27]
  ds_read_b128 v[8:11], v30 offset:26624
  s_waitcnt lgkmcnt(3)
  v_mfma_f32_16x16x32_bf16 v[24:27], v[68:71], v[12:15], v[24:27]
  ds_read_b128 v[12:15], v31 offset:27648
  s_waitcnt lgkmcnt(3)
  v_mfma_f32_16x16x32_bf16 v[24:27], v[72:75], v[16:19], v[24:27]
  ds_read_b128 v[16:19], v30 offset:28672
  s_waitcnt lgkmcnt(3)
  v_mfma_f32_16x16x32_bf16 v[24:27], v[76:79], v[20:23], v[24:27]
  ds_read_b128 v[20:23], v31 offset:29696
  s_waitcnt lgkmcnt(3)
  v_mfma_f32_16x16x32_bf16 v[24:27], v[80:83], v[8:11], v[24:27]
  s_waitcnt lgkmcnt(2)
  v_mfma_f32_16x16x32_bf16 v[24:27], v[84:87], v[12:15], v[24:27]
  s_waitcnt lgkmcnt(1)
  v_mfma_f32_16x16x32_bf16 v[24:27], v[88:91], v[16:19], v[24:27]
  s_waitcnt lgkmcnt(0)
  v_mfma_f32_16x16x32_bf16 v[24:27], v[92:95], v[20:23], v[24:27]
  s_nop 7
  v_exp_f32 v12, v24
  v_exp_f32 v13, v25
  v_exp_f32 v14, v26
  v_exp_f32 v15, v27
  v_max3_f32 v9, v24, v25, v26
  v_cvt_pk_bf16_f32 v16, v12, v13
  v_cvt_pk_bf16_f32 v17, v14, v15
  v_max_f32 v9, v9, v27
  ds_write_b64 v7, v[16:17] offset:4096
  v_cmp_nle_f32 vcc, abs(v9), s50
  s_cmp_lg_u64 vcc, 0
  s_cselect_b32 s48, s49, s48
  s_mov_b64 exec, 1
  v_mov_b32 v8, s48
  ds_add_u32 v1, v8 offset:236
  s_mov_b64 exec, -1
  ds_read_b64_tr_b16 v[108:109], v164 offset:12288
  ds_read_b64_tr_b16 v[110:111], v164 offset:14336
  ds_read_b64_tr_b16 v[124:125], v164 offset:45056
  ds_read_b64_tr_b16 v[126:127], v164 offset:47104
  ds_read_b64_tr_b16 v[140:141], v165 offset:12288
  ds_read_b64_tr_b16 v[142:143], v165 offset:14336
  ds_read_b64_tr_b16 v[156:157], v165 offset:45056
  ds_read_b64_tr_b16 v[158:159], v165 offset:47104
  v_lshrrev_b32 v12, 3, v4
  v_lshl_add_u32 v12, v5, 2, v12
  v_lshlrev_b32 v84, 17, v12
  s_mov_b32 s29, 65536
L_pw_48:
  ds_read_b32 v3, v1 offset:236
  s_waitcnt lgkmcnt(0)
  v_readfirstlane_b32 s42, v3
  s_sub_u32 s29, s29, 1
  s_cbranch_scc1 L_pwo_49
  s_and_b32 s48, s42, 0xff
  s_cmp_eq_u32 s48, 0x22
  s_cbranch_scc0 L_pw_48
L_pwo_49:
  ds_read_b128 v[32:35], v166 offset:4096
  ds_read_b128 v[36:39], v166 offset:5120
  s_waitcnt lgkmcnt(1)
  v_mfma_f32_16x16x32_bf16 v[48:51], v[32:35], v[96:99], 0
  v_and_b32 v12, 7, v4
  v_lshl_add_u32 v84, v12, 4, v84
  v_mfma_f32_16x16x32_bf16 v[52:55], v[32:35], v[112:115], 0
  v_and_b32 v12, 3, v0
  v_lshlrev_b32 v12, 3, v12
  v_mfma_f32_16x16x32_bf16 v[56:59], v[32:35], v[128:131], 0
  v_lshrrev_b32 v12, v12, s45
  v_and_b32 v13, 0xff, v12
  v_mfma_f32_16x16x32_bf16 v[60:63], v[32:35], v[144:147], 0
  v_lshlrev_b32 v12, 15, v13
  v_or_b32 v12, v12, v13
  s_waitcnt lgkmcnt(0)
  v_mfma_f32_16x16x32_bf16 v[48:51], v[36:39], v[100:103], v[48:51]
  v_lshrrev_b32 v13, 0, v12
  v_and_b32 v80, s44, v13
  v_mfma_f32_16x16x32_bf16 v[52:55], v[36:39], v[116:119], v[52:55]
  v_lshrrev_b32 v13, 2, v12
  v_and_b32 v81, s44, v13
  v_mfma_f32_16x16x32_bf16 v[56:59], v[36:39], v[132:135], v[56:59]
  v_lshrrev_b32 v13, 4, v12
  v_and_b32 v82, s44, v13
  v_mfma_f32_16x16x32_bf16 v[60:63], v[36:39], v[148:151], v[60:63]
  v_lshrrev_b32 v13, 6, v12
  v_and_b32 v83, s44, v13
  s_mov_b32 s29, 65536
L_pw_50:
  ds_read_b32 v3, v1 offset:236
  s_waitcnt lgkmcnt(0)
  v_readfirstlane_b32 s42, v3
  s_sub_u32 s29, s29, 1
  s_cbranch_scc1 L_pwo_51
  s_and_b32 s48, s42, 0xffff
  s_cmp_eq_u32 s48, 0x2222
  s_cbranch_scc0 L_pw_50
L_pwo_51:
  ds_read_b128 v[40:43], v166 offset:6144
  ds_read_b128 v[44:47], v166 offset:7168
  s_cmp_lg_u32 s42, 0x2222
  s_cbranch_scc1 L_slow
  s_waitcnt lgkmcnt(1)
  v_mfma_f32_16x16x32_bf16 v[48:51], v[40:43], v[104:107], v[48:51]
  v_mfma_f32_16x16x32_bf16 v[52:55], v[40:43], v[120:123], v[52:55]
  v_mfma_f32_16x16x32_bf16 v[56:59], v[40:43], v[136:139], v[56:59]
  v_mfma_f32_16x16x32_bf16 v[60:63], v[40:43], v[152:155], v[60:63]
  s_waitcnt lgkmcnt(0)
  v_mfma_f32_16x16x32_bf16 v[48:51], v[44:47], v[108:111], v[48:51]
  v_mfma_f32_16x16x32_bf16 v[52:55], v[44:47], v[124:127], v[52:55]
  v_mfma_f32_16x16x32_bf16 v[56:59], v[44:47], v[140:143], v[56:59]
  v_mfma_f32_16x16x32_bf16 v[60:63], v[44:47], v[156:159], v[60:63]
L_pv2:
  s_nop 6
  v_perm_b32 v64, v52, v48, s101
  v_perm_b32 v66, v53, v49, s101
  v_perm_b32 v65, v60, v56, s101
  v_perm_b32 v67, v61, v57, s101
  s_nop 0
  v_mov_b32_dpp v72, v64 row_ror:8 row_mask:0xf bank_mask:0xf
  v_mov_b32_dpp v73, v65 row_ror:8 row_mask:0xf bank_mask:0xf
  v_mov_b32_dpp v64, v66 row_ror:8 row_mask:0xf bank_mask:0xc
  v_mov_b32_dpp v65, v67 row_ror:8 row_mask:0xf bank_mask:0xc
  v_mov_b32_dpp v66, v72 quad_perm:[0,1,2,3] row_mask:0xf bank_mask:0x3
  v_mov_b32_dpp v67, v73 quad_perm:[0,1,2,3] row_mask:0xf bank_mask:0x3
  v_add_u32 v64, s44, v64
  v_add_u32 v65, s44, v65
  v_add_u32 v66, s44, v66
  v_add_u32 v67, s44, v67
  v_bfi_b32 v64, s44, v80, v64
  v_bfi_b32 v65, s44, v81, v65
  v_bfi_b32 v66, s44, v82, v66
  v_bfi_b32 v67, s44, v83, v67
  buffer_store_dwordx4 v[64:67], v84, s[4:7], s26 offen sc1
  v_perm_b32 v68, v54, v50, s101
  v_perm_b32 v70, v55, v51, s101
  v_perm_b32 v69, v62, v58, s101
  v_perm_b32 v71, v63, v59, s101
  s_nop 0
  v_mov_b32_dpp v72, v68 row_ror:8 row_mask:0xf bank_mask:0xf
  v_mov_b32_dpp v73, v69 row_ror:8 row_mask:0xf bank_mask:0xf
  v_mov_b32_dpp v68, v70 row_ror:8 row_mask:0xf bank_mask:0xc
  v_mov_b32_dpp v69, v71 row_ror:8 row_mask:0xf bank_mask:0xc
  v_mov_b32_dpp v70, v72 quad_perm:[0,1,2,3] row_mask:0xf bank_mask:0x3
  v_mov_b32_dpp v71, v73 quad_perm:[0,1,2,3] row_mask:0xf bank_mask:0x3
  v_add_u32 v68, s44, v68
  v_add_u32 v69, s44, v69
  v_add_u32 v70, s44, v70
  v_add_u32 v71, s44, v71
  v_bfi_b32 v68, s44, v80, v68
  v_bfi_b32 v69, s44, v81, v69
  v_bfi_b32 v70, s44, v82, v70
  v_bfi_b32 v71, s44, v83, v71
  buffer_store_dwordx4 v[68:71], v84, s[4:7], s22 offen sc1
  s_mov_b64 exec, 1
  ds_add_u32 v1, v2 offset:192
  s_mov_b64 exec, -1
  s_setprio 0
  v_and_b32 v12, 1, v0
  v_lshlrev_b32 v12, 4, v12
  v_mov_b32 v13, 0xffff
  v_lshlrev_b32 v13, v12, v13
  v_bfe_u32 v12, v0, 1, 2
  v_cmp_eq_u32 vcc, 0, v12
  s_nop 1
  v_cndmask_b32 v76, v1, v13, vcc
  v_cmp_eq_u32 vcc, 1, v12
  s_nop 1
  v_cndmask_b32 v77, v1, v13, vcc
  v_cmp_eq_u32 vcc, 2, v12
  s_nop 1
  v_cndmask_b32 v78, v1, v13, vcc
  v_cmp_eq_u32 vcc, 3, v12
  s_nop 1
  v_cndmask_b32 v79, v1, v13, vcc
  v_lshlrev_b32 v16, 2, v4
  s_lshl_b32 s42, s3, 6
  v_add_u32 v16, s42, v16
  v_lshrrev_b32 v17, 3, v0
  v_lshlrev_b32 v17, 2, v17
  v_add_u32 v17, s42, v17
  v_lshrrev_b32 v18, 3, v4
  s_lshl_b32 s42, s3, 1
  v_add_u32 v19, s42, v18
  v_mul_u32_u24 v19, 144, v19
  v_and_b32 v20, 7, v4
  v_lshl_add_u32 v19, v20, 4, v19
  v_and_b32 v20, 1, v5
  v_lshl_add_u32 v19, v20, 3, v19
  v_lshrrev_b32 v20, 1, v5
  v_cmp_eq_u32 s[46:47], v18, v20
  v_lshlrev_b32 v14, 3, v0
  s_add_u32 s24, s4, s31
  s_addc_u32 s25, s5, 0
  s_and_b32 s20, s15, 0
  s_lshl_b32 s20, s20, 15
  s_add_u32 s20, s20, s24
  s_addc_u32 s21, s25, 0
  s_lshl_b32 s18, s28, 4
  v_and_b32 v88, 0x3f803f80, v76
  v_and_b32 v89, 0x3f803f80, v77
  v_and_b32 v90, 0x3f803f80, v78
  v_and_b32 v91, 0x3f803f80, v79
  v_and_b32 v92, 0x3f803f80, v76
  v_and_b32 v93, 0x3f803f80, v77
  v_and_b32 v94, 0x3f803f80, v78
  v_and_b32 v95, 0x3f803f80, v79
  s_sleep 12
  s_setprio 2
  s_mov_b32 s43, 8192
  s_branch L_h3lf_54
L_h3l_52:
  s_sleep 4
L_h3lf_54:
  s_load_dwordx16 s[52:67], s[20:21], 32768 glc
  s_load_dwordx16 s[68:83], s[20:21], 32832 glc
  s_sub_u32 s43, s43, 1
  s_cbranch_scc1 L_h3lo_53
  s_waitcnt lgkmcnt(0)
  s_add_u32 s19, s53, s55
  s_add_u32 s19, s19, s57
  s_add_u32 s19, s19, s59
  s_add_u32 s19, s19, s61
  s_add_u32 s19, s19, s63
  s_add_u32 s19, s19, s65
  s_add_u32 s19, s19, s67
  s_add_u32 s19, s19, s69
  s_add_u32 s19, s19, s71
  s_add_u32 s19, s19, s73
  s_add_u32 s19, s19, s75
  s_add_u32 s19, s19, s77
  s_add_u32 s19, s19, s79
  s_add_u32 s19, s19, s81
  s_add_u32 s19, s19, s83
  s_cmp_eq_u32 s19, s18
  s_cbranch_scc0 L_h3l_52
L_h3lo_53:
  s_waitcnt lgkmcnt(0)
  buffer_load_dwordx4 v[104:107], v166, s[4:7], s30 offen sc1
  buffer_load_dwordx4 v[108:111], v166, s[4:7], s30 offen offset:1024 sc1
  v_writelane_b32 v24, s52, 0
  v_writelane_b32 v24, s54, 1
  v_writelane_b32 v24, s56, 2
  v_writelane_b32 v24, s58, 3
  v_writelane_b32 v24, s60, 4
  v_writelane_b32 v24, s62, 5
  v_writelane_b32 v24, s64, 6
  v_writelane_b32 v24, s66, 7
  v_writelane_b32 v24, s68, 8
  v_writelane_b32 v24, s70, 9
  v_writelane_b32 v24, s72, 10
  v_writelane_b32 v24, s74, 11
  v_writelane_b32 v24, s76, 12
  v_writelane_b32 v24, s78, 13
  v_writelane_b32 v24, s80, 14
  v_writelane_b32 v24, s82, 15
  s_mov_b64 exec, 0xffff
  v_cmp_gt_i32 vcc, 0, v24
  s_cmp_lg_u64 vcc, 0
  s_cselect_b32 s42, 0x101, 1
  v_mov_b32 v25, s42
  ds_write_b32 v16, v24 offset:11264
  s_mov_b64 exec, 1
  ds_add_u32 v1, v25 offset:220
  s_mov_b64 exec, -1
  s_mov_b32 s29, 65536
L_pw_55:
  ds_read_b32 v3, v1 offset:220
  s_waitcnt lgkmcnt(0)
  v_readfirstlane_b32 s42, v3
  s_sub_u32 s29, s29, 1
  s_cbranch_scc1 L_pwo_56
  s_and_b32 s43, s42, 0xff
  s_cmp_eq_u32 s43, 0x8
  s_cbranch_scc0 L_pw_55
L_pwo_56:
  s_cmp_lg_u32 s42, 8
  s_cbranch_scc1 L_genw
L_genw_ret:
  s_mov_b32 s43, 8192
L_h3d_57:
  s_waitcnt vmcnt(0)
  v_xor_b32 v104, v104, v80
  v_xor_b32 v105, v105, v81
  v_xor_b32 v106, v106, v82
  v_xor_b32 v107, v107, v83
  v_xor_b32 v108, v108, v80
  v_xor_b32 v109, v109, v81
  v_xor_b32 v110, v110, v82
  v_xor_b32 v111, v111, v83
  v_or3_b32 v3, v104, v105, v106
  v_or3_b32 v12, v107, v108, v109
  v_or3_b32 v3, v3, v110, v111
  v_bitop3_b32 v3, v3, v12, s44 bitop3:0xa8
  v_cmp_ne_u32 vcc, 0, v3
  s_cbranch_vccz L_h3do_58
  s_sub_u32 s43, s43, 1
  s_cbranch_scc1 L_h3do_58
  s_lshr_b64 s[48:49], vcc, 4
  s_or_b64 vcc, vcc, s[48:49]
  s_lshr_b64 s[48:49], vcc, 2
  s_or_b64 vcc, vcc, s[48:49]
  s_lshr_b64 s[48:49], vcc, 1
  s_or_b64 vcc, vcc, s[48:49]
  s_and_b32 s48, vcc_lo, 0x01010101
  s_and_b32 s49, vcc_hi, 0x01010101
  s_mul_i32 exec_lo, s48, 0xff
  s_mul_i32 exec_hi, s49, 0xff
  s_sleep 2
  buffer_load_dwordx4 v[104:107], v166, s[4:7], s30 offen sc1
  buffer_load_dwordx4 v[108:111], v166, s[4:7], s30 offen offset:1024 sc1
  s_branch L_h3d_57
L_h3do_58:
  s_mov_b64 exec, -1
  v_mfma_f32_16x16x32_bf16 v[96:99], v[88:91], v[104:107], 0
  v_mfma_f32_16x16x32_bf16 v[96:99], v[92:95], v[108:111], v[96:99]
  s_nop 7
  v_cvt_pk_bf16_f32 v100, v96, v97
  v_cvt_pk_bf16_f32 v101, v98, v99
  s_mov_b64 exec, s[46:47]
  ds_write_b64 v19, v[100:101] offset:8192
  s_mov_b64 exec, 1
  ds_add_u32 v1, v2 offset:32
  s_mov_b64 exec, -1
  s_cmp_lt_u32 s2, 20
  s_cbranch_scc0 L_A_end
  s_lshl_b32 s41, s2, 14
  s_lshl_b32 s42, s3, 11
  s_add_u32 s41, s41, s42
  s_add_u32 s41, s41, 937984
  v_and_b32 v7, 7, v0
  v_lshlrev_b32 v7, 2, v7
  v_lshrrev_b32 v6, 5, v0
  v_lshl_add_u32 v7, v6, 1, v7
  v_and_b32 v6, 1, v5
  v_add_u32 v7, v7, v6
  v_lshlrev_b32 v18, 5, v7
  s_lshl_b32 s42, s3, 2
  v_add_u32 v6, s42, v18
  v_lshlrev_b32 v7, 1, v7
  s_lshl_b32 s55, s2, 6
  s_and_b32 s66, s28, 1
  s_mul_i32 s66, s66, 0x01010101
  s_and_b32 s67, s28, 0xfefefefe
  s_or_b32 s66, s66, s67
  s_bfe_u32 s67, s66, 0x80008
  s_bfe_u32 s68, s66, 0x80010
  s_lshr_b32 s69, s66, 24
  s_and_b32 s66, s66, 0xff
  s_cmp_eq_u32 s3, 0
  s_cbranch_scc0 L_fin_s
  s_mov_b32 s8, s16
  s_mov_b32 s9, s17
  s_mov_b32 s10, 1280
  s_mov_b32 s11, 0x20000
  buffer_load_ushort v16, v7, s[8:11], s55 offen
  s_lshl_b32 s40, s2, 12
  s_add_u32 s40, s40, 856064
  s_mov_b32 s43, 8192
L_h7_59:
  v_mov_b32 v60, s66
  v_mov_b32 v61, s67
  v_mov_b32 v62, s68
  v_mov_b32 v63, s69
  buffer_load_dwordx4 v[48:51], v166, s[4:7], s40 offen sc1
  buffer_load_dwordx4 v[52:55], v166, s[4:7], s40 offen offset:1024 sc1
  buffer_load_dwordx4 v[56:59], v166, s[4:7], s40 offen offset:2048 sc1
  s_mov_b64 exec, 0xffffff
  buffer_load_dwordx4 v[60:63], v166, s[4:7], s40 offen offset:3072 sc1
  s_mov_b64 exec, -1
  s_waitcnt vmcnt(0)
  v_xor_b32 v48, s66, v48
  v_xor_b32 v49, s67, v49
  v_xor_b32 v50, s68, v50
  v_xor_b32 v51, s69, v51
  v_xor_b32 v52, s66, v52
  v_xor_b32 v53, s67, v53
  v_xor_b32 v54, s68, v54
  v_xor_b32 v55, s69, v55
  v_xor_b32 v56, s66, v56
  v_xor_b32 v57, s67, v57
  v_xor_b32 v58, s68, v58
  v_xor_b32 v59, s69, v59
  v_xor_b32 v60, s66, v60
  v_xor_b32 v61, s67, v61
  v_xor_b32 v62, s68, v62
  v_xor_b32 v63, s69, v63
  v_or_b32 v3, v48, v49
  v_or3_b32 v3, v3, v50, v51
  v_or3_b32 v3, v3, v52, v53
  v_or3_b32 v3, v3, v54, v55
  v_or3_b32 v3, v3, v56, v57
  v_or3_b32 v3, v3, v58, v59
  v_or3_b32 v3, v3, v60, v61
  v_or3_b32 v3, v3, v62, v63
  v_and_b32 v3, 0xff, v3
  v_cmp_ne_u32 vcc, 0, v3
  s_cbranch_vccz L_h7o_60
  s_sleep 4
  s_sub_u32 s43, s43, 1
  s_cbranch_scc0 L_h7_59
L_h7o_60:
  v_pk_add_f32 v[48:49], v[48:49], v[52:53]
  v_pk_add_f32 v[50:51], v[50:51], v[54:55]
  v_pk_add_f32 v[56:57], v[56:57], v[60:61]
  v_pk_add_f32 v[58:59], v[58:59], v[62:63]
  v_pk_add_f32 v[48:49], v[48:49], v[56:57]
  v_pk_add_f32 v[50:51], v[50:51], v[58:59]
  s_nop 1
  v_permlane32_swap_b32 v48, v50
  v_permlane32_swap_b32 v49, v51
  v_pk_add_f32 v[48:49], v[48:49], v[50:51]
  s_nop 1
  v_permlane16_swap_b32 v48, v49
  v_add_f32 v48, v48, v49
  s_nop 1
  v_add_f32_dpp v48, v48, v48 row_ror:8 row_mask:0xf bank_mask:0xf
  v_cvt_pk_bf16_f32 v48, v48, v48
  v_and_b32 v48, 0xffff0000, v48
  v_mul_f32 v49, 0xbfb8aa3b, v48
  v_exp_f32 v49, v49
  s_nop 0
  v_add_f32 v49, 1.0, v49
  v_rcp_f32 v49, v49
  s_nop 0
  v_mul_f32 v48, v48, v49
  v_cvt_pk_bf16_f32 v48, v48, v48
  v_and_b32 v48, 0xffff0000, v48
  v_lshlrev_b32 v20, 16, v16
L_fin_s:
  s_mov_b32 s29, 65536
  s_branch L_wf_63
L_w_61:
  s_sleep 1
L_wf_63:
  ds_read_b32 v3, v1 offset:56
  s_waitcnt lgkmcnt(0)
  v_readfirstlane_b32 s42, v3
  s_sub_u32 s29, s29, 1
  s_cbranch_scc1 L_wo_62
  s_cmp_ge_u32 s42, 4
  s_cbranch_scc0 L_w_61
L_wo_62:
  s_sleep 8
  s_mov_b32 s43, 8192
L_h5_64:
  buffer_load_dwordx4 v[32:35], v166, s[4:7], s41 offen sc1
  buffer_load_dwordx4 v[36:39], v166, s[4:7], s41 offen offset:1024 sc1
  s_waitcnt vmcnt(0)
  v_xor_b32 v32, s66, v32
  v_xor_b32 v33, s67, v33
  v_xor_b32 v34, s68, v34
  v_xor_b32 v35, s69, v35
  v_xor_b32 v36, s66, v36
  v_xor_b32 v37, s67, v37
  v_xor_b32 v38, s68, v38
  v_xor_b32 v39, s69, v39
  v_or_b32 v3, v32, v33
  v_or3_b32 v3, v3, v34, v35
  v_or3_b32 v3, v3, v36, v37
  v_or3_b32 v3, v3, v38, v39
  v_and_b32 v3, 0xff, v3
  v_cmp_ne_u32 vcc, 0, v3
  s_cbranch_vccz L_h5o_65
  s_mov_b64 exec, vcc
  s_sleep 3
  s_sub_u32 s43, s43, 1
  s_cbranch_scc0 L_h5_64
L_h5o_65:
  s_mov_b64 exec, -1
  v_pk_add_f32 v[32:33], v[32:33], v[36:37]
  v_pk_add_f32 v[34:35], v[34:35], v[38:39]
  s_nop 1
  v_permlane32_swap_b32 v32, v34
  v_permlane32_swap_b32 v33, v35
  v_pk_add_f32 v[32:33], v[32:33], v[34:35]
  s_nop 1
  v_permlane16_swap_b32 v32, v33
  v_add_f32 v32, v32, v33
  s_nop 1
  v_add_f32_dpp v32, v32, v32 row_ror:8 row_mask:0xf bank_mask:0xf
  ds_write_b32 v6, v32 offset:4096
  s_mov_b64 exec, 1
  ds_add_u32 v1, v2 offset:60
  s_mov_b64 exec, -1
  s_cmp_eq_u32 s3, 0
  s_cbranch_scc0 L_A_end
  s_mov_b32 s44, s34
  s_mov_b32 s45, s35
  s_mov_b32 s46, 1280
  s_mov_b32 s47, 0x20000
  s_mov_b32 s29, 65536
L_w_66:
  ds_read_b32 v3, v1 offset:60
  ds_read_b128 v[32:35], v18 offset:4096
  ds_read_b128 v[36:39], v18 offset:4112
  s_waitcnt lgkmcnt(0)
  v_readfirstlane_b32 s42, v3
  s_sub_u32 s29, s29, 1
  s_cbranch_scc1 L_wo_67
  s_cmp_ge_u32 s42, 8
  s_cbranch_scc0 L_w_66
L_wo_67:
  v_pk_add_f32 v[32:33], v[32:33], v[36:37]
  v_pk_add_f32 v[34:35], v[34:35], v[38:39]
  v_pk_add_f32 v[32:33], v[32:33], v[34:35]
  v_add_f32 v32, v32, v33
  v_cvt_pk_bf16_f32 v32, v32, v32
  v_and_b32 v32, 0xffff0000, v32
  v_mul_f32 v32, v32, v48
  v_cvt_pk_bf16_f32 v32, v32, v32
  v_and_b32 v32, 0xffff0000, v32
  v_add_f32 v32, v32, v20
  v_cvt_pk_bf16_f32 v32, v32, v32
  buffer_store_short v32, v7, s[44:47], s55 offen sc1
  s_cmp_eq_u32 s2, 0
  s_cbranch_scc0 L_noep
  s_mov_b64 exec, 1
  v_mov_b32 v13, s28
  buffer_store_dword v13, v1, s[4:7], 0 offen offset:0 sc1
L_noep:
L_A_end:
  s_endpgm
L_h1v_32:
  v_and_b32 v11, 31, v0
  v_lshlrev_b32 v11, 3, v11
  s_mov_b32 s19, 8192
L_h1p_68:
  buffer_load_dwordx2 v[12:13], v11, s[4:7], s25 offen sc1
  s_waitcnt vmcnt(0)
  v_xor_b32 v3, s28, v13
  v_cmp_ne_u32 vcc, 0, v3
  s_cbranch_vccz L_h1po_69
  s_mov_b64 exec, vcc
  s_sleep 2
  s_sub_u32 s19, s19, 1
  s_cbranch_scc0 L_h1p_68
L_h1po_69:
  s_mov_b64 exec, -1
  v_readlane_b32 s36, v12, 0
  v_readlane_b32 s38, v12, 1
  v_readlane_b32 s40, v12, 2
  v_readlane_b32 s42, v12, 3
  v_readlane_b32 s44, v12, 4
  v_readlane_b32 s46, v12, 5
  v_readlane_b32 s48, v12, 6
  v_readlane_b32 s50, v12, 7
  v_readlane_b32 s52, v12, 8
  v_readlane_b32 s54, v12, 9
  v_readlane_b32 s56, v12, 10
  v_readlane_b32 s58, v12, 11
  v_readlane_b32 s60, v12, 12
  v_readlane_b32 s62, v12, 13
  v_readlane_b32 s64, v12, 14
  v_readlane_b32 s66, v12, 15
  v_readlane_b32 s68, v12, 16
  v_readlane_b32 s70, v12, 17
  v_readlane_b32 s72, v12, 18
  v_readlane_b32 s74, v12, 19
  v_readlane_b32 s76, v12, 20
  v_readlane_b32 s78, v12, 21
  v_readlane_b32 s80, v12, 22
  v_readlane_b32 s82, v12, 23
  v_readlane_b32 s84, v12, 24
  v_readlane_b32 s86, v12, 25
  v_readlane_b32 s88, v12, 26
  v_readlane_b32 s90, v12, 27
  v_readlane_b32 s92, v12, 28
  v_readlane_b32 s94, v12, 29
  v_readlane_b32 s96, v12, 30
  v_readlane_b32 s98, v12, 31
  s_nop 1
  s_branch L_h1o_30
L_genw:
  s_mov_b32 s43, 8192
  s_branch L_h3mf_72
L_h3m_70:
  s_sleep 4
L_h3mf_72:
  s_load_dwordx16 s[52:67], s[24:25], 0 glc
  s_load_dwordx16 s[68:83], s[24:25], 64 glc
  s_sub_u32 s43, s43, 1
  s_cbranch_scc1 L_h3mo_71
  s_waitcnt lgkmcnt(0)
  s_add_u32 s19, s53, s55
  s_add_u32 s19, s19, s57
  s_add_u32 s19, s19, s59
  s_add_u32 s19, s19, s61
  s_add_u32 s19, s19, s63
  s_add_u32 s19, s19, s65
  s_add_u32 s19, s19, s67
  s_add_u32 s19, s19, s69
  s_add_u32 s19, s19, s71
  s_add_u32 s19, s19, s73
  s_add_u32 s19, s19, s75
  s_add_u32 s19, s19, s77
  s_add_u32 s19, s19, s79
  s_add_u32 s19, s19, s81
  s_add_u32 s19, s19, s83
  s_cmp_eq_u32 s19, s18
  s_cbranch_scc0 L_h3m_70
L_h3mo_71:
  s_waitcnt lgkmcnt(0)
  v_writelane_b32 v24, s52, 0
  v_writelane_b32 v24, s54, 1
  v_writelane_b32 v24, s56, 2
  v_writelane_b32 v24, s58, 3
  v_writelane_b32 v24, s60, 4
  v_writelane_b32 v24, s62, 5
  v_writelane_b32 v24, s64, 6
  v_writelane_b32 v24, s66, 7
  v_writelane_b32 v24, s68, 8
  v_writelane_b32 v24, s70, 9
  v_writelane_b32 v24, s72, 10
  v_writelane_b32 v24, s74, 11
  v_writelane_b32 v24, s76, 12
  v_writelane_b32 v24, s78, 13
  v_writelane_b32 v24, s80, 14
  v_writelane_b32 v24, s82, 15
  s_mov_b64 exec, 0xffff
  ds_write_b32 v16, v24 offset:10752
  s_mov_b64 exec, 1
  ds_add_u32 v1, v2 offset:196
  s_mov_b64 exec, -1
  s_mov_b32 s29, 65536
L_w_73:
  ds_read_b32 v3, v1 offset:196
  s_waitcnt lgkmcnt(0)
  v_readfirstlane_b32 s42, v3
  s_sub_u32 s29, s29, 1
  s_cbranch_scc1 L_wo_74
  s_cmp_ge_u32 s42, 8
  s_cbranch_scc0 L_w_73
L_wo_74:
  ds_read_b64 v[24:25], v14 offset:10752
  ds_read_b32 v8, v17 offset:10752
  ds_read_b32 v9, v17 offset:10784
  s_waitcnt lgkmcnt(0)
  v_max_f32 v22, v24, v25
  s_nop 1
  v_max_f32_dpp v22, v22, v22 quad_perm:[1,0,3,2] row_mask:0xf bank_mask:0xf
  s_nop 1
  v_max_f32_dpp v22, v22, v22 quad_perm:[2,3,0,1] row_mask:0xf bank_mask:0xf
  s_nop 1
  v_max_f32_dpp v22, v22, v22 row_half_mirror row_mask:0xf bank_mask:0xf
  s_nop 1
  v_max_f32_dpp v22, v22, v22 row_mirror row_mask:0xf bank_mask:0xf
  v_mov_b32 v23, v22
  s_nop 1
  v_permlane16_swap_b32 v22, v23
  v_max_f32 v22, v22, v23
  v_mov_b32 v23, v22
  s_nop 1
  v_permlane32_swap_b32 v22, v23
  v_max_f32 v22, v22, v23
  v_sub_f32 v8, v8, v22
  v_sub_f32 v9, v9, v22
  v_exp_f32 v8, v8
  v_exp_f32 v9, v9
  s_nop 0
  v_cvt_pk_bf16_f32 v8, v8, v8
  v_cvt_pk_bf16_f32 v9, v9, v9
  v_and_b32 v88, v8, v76
  v_and_b32 v89, v8, v77
  v_and_b32 v90, v8, v78
  v_and_b32 v91, v8, v79
  v_and_b32 v92, v9, v76
  v_and_b32 v93, v9, v77
  v_and_b32 v94, v9, v78
  v_and_b32 v95, v9, v79
  s_branch L_genw_ret
L_slow:
  v_mov_b32 v8, v9
  v_lshlrev_b32 v6, 5, v4
  s_lshl_b32 s42, s3, 2
  v_add_u32 v29, s42, v6
  s_mov_b32 s43, 0x3f803f80
  v_permlane16_swap_b32 v9, v8
  v_max_f32 v9, v9, v8
  v_mov_b32 v8, v9
  s_nop 1
  v_permlane32_swap_b32 v9, v8
  v_max_f32 v9, v9, v8
  s_mov_b64 exec, 0xffff
  ds_write_b32 v29, v9 offset:11776
  s_mov_b64 exec, 1
  ds_add_u32 v1, v2 offset:24
  s_mov_b64 exec, -1
  s_mov_b32 s29, 65536
L_w_75:
  ds_read_b32 v3, v1 offset:24
  ds_read_b128 v[12:15], v6 offset:11776
  ds_read_b128 v[16:19], v6 offset:11792
  s_waitcnt lgkmcnt(0)
  v_readfirstlane_b32 s42, v3
  s_sub_u32 s29, s29, 1
  s_cbranch_scc1 L_wo_76
  s_cmp_ge_u32 s42, 8
  s_cbranch_scc0 L_w_75
L_wo_76:
  v_max3_f32 v10, v12, v13, v14
  v_max3_f32 v16, v15, v16, v17
  v_max3_f32 v10, v10, v18, v19
  v_max_f32 v10, v10, v16
  v_sub_f32 v24, v24, v10
  v_sub_f32 v25, v25, v10
  v_sub_f32 v26, v26, v10
  v_sub_f32 v27, v27, v10
  v_exp_f32 v24, v24
  v_exp_f32 v25, v25
  v_exp_f32 v26, v26
  v_exp_f32 v27, v27
  v_lshlrev_b32 v15, 10, v4
  v_cvt_pk_bf16_f32 v12, v24, v25
  v_cvt_pk_bf16_f32 v13, v26, v27
  ds_write_b64 v7, v[12:13] offset:4096
  s_mov_b64 exec, 1
  ds_add_u32 v1, v2 offset:28
  s_mov_b64 exec, -1
  s_mov_b32 s29, 65536
L_w_77:
  ds_read_b32 v3, v1 offset:28
  s_waitcnt lgkmcnt(0)
  v_readfirstlane_b32 s42, v3
  s_sub_u32 s29, s29, 1
  s_cbranch_scc1 L_wo_78
  s_cmp_ge_u32 s42, 8
  s_cbranch_scc0 L_w_77
L_wo_78:
  ds_read_b128 v[32:35], v166 offset:4096
  ds_read_b128 v[36:39], v166 offset:5120
  ds_read_b128 v[40:43], v166 offset:6144
  ds_read_b128 v[44:47], v166 offset:7168
  v_mov_b32 v12, 0
  v_mov_b32 v14, 0
  s_waitcnt lgkmcnt(0)
  v_mfma_f32_16x16x32_bf16 v[48:51], v[32:35], v[96:99], 0
  v_dot2c_f32_bf16 v12, s43, v32
  v_mfma_f32_16x16x32_bf16 v[52:55], v[32:35], v[112:115], 0
  v_dot2c_f32_bf16 v14, s43, v33
  v_mfma_f32_16x16x32_bf16 v[56:59], v[32:35], v[128:131], 0
  v_dot2c_f32_bf16 v12, s43, v34
  v_mfma_f32_16x16x32_bf16 v[60:63], v[32:35], v[144:147], 0
  v_dot2c_f32_bf16 v14, s43, v35
  v_mfma_f32_16x16x32_bf16 v[48:51], v[36:39], v[100:103], v[48:51]
  v_dot2c_f32_bf16 v12, s43, v36
  v_mfma_f32_16x16x32_bf16 v[52:55], v[36:39], v[116:119], v[52:55]
  v_dot2c_f32_bf16 v14, s43, v37
  v_mfma_f32_16x16x32_bf16 v[56:59], v[36:39], v[132:135], v[56:59]
  v_dot2c_f32_bf16 v12, s43, v38
  v_mfma_f32_16x16x32_bf16 v[60:63], v[36:39], v[148:151], v[60:63]
  v_dot2c_f32_bf16 v14, s43, v39
  v_mfma_f32_16x16x32_bf16 v[48:51], v[40:43], v[104:107], v[48:51]
  v_dot2c_f32_bf16 v12, s43, v40
  v_mfma_f32_16x16x32_bf16 v[52:55], v[40:43], v[120:123], v[52:55]
  v_dot2c_f32_bf16 v14, s43, v41
  v_mfma_f32_16x16x32_bf16 v[56:59], v[40:43], v[136:139], v[56:59]
  v_dot2c_f32_bf16 v12, s43, v42
  v_mfma_f32_16x16x32_bf16 v[60:63], v[40:43], v[152:155], v[60:63]
  v_dot2c_f32_bf16 v14, s43, v43
  v_mfma_f32_16x16x32_bf16 v[48:51], v[44:47], v[108:111], v[48:51]
  v_dot2c_f32_bf16 v12, s43, v44
  v_mfma_f32_16x16x32_bf16 v[52:55], v[44:47], v[124:127], v[52:55]
  v_dot2c_f32_bf16 v14, s43, v45
  v_mfma_f32_16x16x32_bf16 v[56:59], v[44:47], v[140:143], v[56:59]
  v_dot2c_f32_bf16 v12, s43, v46
  v_mfma_f32_16x16x32_bf16 v[60:63], v[44:47], v[156:159], v[60:63]
  v_dot2c_f32_bf16 v14, s43, v47
  v_mov_b32 v13, s28
  v_mov_b32 v11, s28
  s_nop 0
  v_add_f32 v12, v12, v14
  v_mov_b32 v14, v12
  s_nop 1
  v_permlane16_swap_b32 v12, v14
  v_add_f32 v12, v12, v14
  v_mov_b32 v14, v12
  s_nop 1
  v_permlane32_swap_b32 v12, v14
  v_add_f32 v12, v12, v14
  v_or_b32 v12, 0x80000000, v12
  s_cmp_eq_u32 s3, 0
  s_cbranch_scc0 L_pv2
  s_mov_b64 exec, 0xffff
  buffer_store_dwordx2 v[10:11], v15, s[4:7], s27 offen sc1
  s_mov_b64 exec, -1
  v_lshl_add_u32 v14, v5, 15, v15
  s_mov_b64 exec, 0xffff
  buffer_store_dwordx2 v[12:13], v14, s[4:7], s23 offen sc1
  s_mov_b64 exec, -1
  s_branch L_pv2
L_G:
  s_mov_b32 s29, 65536
L_w_79:
  ds_read_b32 v3, v1 offset:44
  ds_read_b32 v6, v1 offset:40
  s_waitcnt lgkmcnt(0)
  v_readfirstlane_b32 s28, v3
  s_sub_u32 s29, s29, 1
  s_cbranch_scc1 L_wo_80
  s_cmp_ge_u32 s28, 1
  s_cbranch_scc0 L_w_79
L_wo_80:
  v_readfirstlane_b32 s28, v6
  s_cmp_eq_u32 s3, 10
  s_cbranch_scc1 L_G_uv10
  v_mul_u32_u24 v6, 10240, v5
  v_lshl_add_u32 v6, v4, 3, v6
  s_lshl_b32 s40, s14, 7
  s_lshr_b32 s41, s15, 1
  s_lshl_b32 s41, s41, 5
  s_add_u32 s40, s40, s41
  s_mul_i32 s40, s40, 1280
  s_and_b32 s41, s15, 1
  s_mul_i32 s41, s41, 640
  s_add_u32 s48, s40, s41
  s_mov_b32 s44, s26
  s_mov_b32 s45, s27
  s_mov_b32 s46, 5242880
  s_mov_b32 s47, 0x20000
  v_and_b32 v31, 7, v4
  v_lshlrev_b32 v29, 7, v31
  v_lshl_add_u32 v29, v5, 5, v29
  s_lshl_b32 s50, s14, 2
  s_lshr_b32 s51, s15, 1
  s_add_u32 s50, s50, s51
  s_lshl_b32 s61, s50, 10
  s_add_u32 s61, s61, 659456
  v_lshrrev_b32 v30, 3, v4
  v_lshlrev_b32 v30, 14, v30
  v_lshl_add_u32 v30, v31, 4, v30
  v_mov_b32 v31, 0xff
  s_and_b32 s41, s15, 1
  s_mul_i32 s41, s41, 163840
  s_lshl_b32 s50, s50, 7
  s_add_u32 s50, s50, s41
  s_add_u32 s50, s50, 937984
  s_and_b32 s66, s28, 1
  s_mul_i32 s66, s66, 0x01010101
  s_and_b32 s67, s28, 0xfefefefe
  s_or_b32 s66, s66, s67
  s_bfe_u32 s67, s66, 0x80008
  s_bfe_u32 s68, s66, 0x80010
  s_lshr_b32 s69, s66, 24
  s_and_b32 s66, s66, 0xff
  buffer_load_dwordx4 v[8:11], v29, s[4:7], s61 offen sc1
  s_add_u32 s51, s50, 0
  buffer_load_dwordx4 v[12:15], v30, s[4:7], s51 offen sc1
  s_add_u32 s51, s50, 32768
  buffer_load_dwordx4 v[12:15], v30, s[4:7], s51 offen sc1
  s_waitcnt vmcnt(31)
  buffer_load_dwordx2 v[32:33], v6, s[44:47], s48 offen nt
  s_waitcnt vmcnt(31)
  buffer_load_dwordx2 v[34:35], v6, s[44:47], s48 offen offset:1280 nt
  s_waitcnt vmcnt(31)
  buffer_load_dwordx2 v[36:37], v6, s[44:47], s48 offen offset:2560 nt
  s_waitcnt vmcnt(31)
  buffer_load_dwordx2 v[38:39], v6, s[44:47], s48 offen offset:3840 nt
  s_add_u32 s42, s48, 5120
  s_waitcnt vmcnt(31)
  buffer_load_dwordx2 v[40:41], v6, s[44:47], s42 offen nt
  s_waitcnt vmcnt(31)
  buffer_load_dwordx2 v[42:43], v6, s[44:47], s42 offen offset:1280 nt
  s_waitcnt vmcnt(31)
  buffer_load_dwordx2 v[44:45], v6, s[44:47], s42 offen offset:2560 nt
  s_waitcnt vmcnt(31)
  buffer_load_dwordx2 v[46:47], v6, s[44:47], s42 offen offset:3840 nt
  s_add_u32 s49, s48, 128
  s_waitcnt vmcnt(31)
  buffer_load_dwordx2 v[48:49], v6, s[44:47], s49 offen nt
  s_waitcnt vmcnt(31)
  buffer_load_dwordx2 v[50:51], v6, s[44:47], s49 offen offset:1280 nt
  s_waitcnt vmcnt(31)
  buffer_load_dwordx2 v[52:53], v6, s[44:47], s49 offen offset:2560 nt
  s_waitcnt vmcnt(31)
  buffer_load_dwordx2 v[54:55], v6, s[44:47], s49 offen offset:3840 nt
  s_add_u32 s42, s49, 5120
  s_waitcnt vmcnt(31)
  buffer_load_dwordx2 v[56:57], v6, s[44:47], s42 offen nt
  s_waitcnt vmcnt(31)
  buffer_load_dwordx2 v[58:59], v6, s[44:47], s42 offen offset:1280 nt
  s_waitcnt vmcnt(31)
  buffer_load_dwordx2 v[60:61], v6, s[44:47], s42 offen offset:2560 nt
  s_waitcnt vmcnt(31)
  buffer_load_dwordx2 v[62:63], v6, s[44:47], s42 offen offset:3840 nt
  v_lshlrev_b32 v16, 3, v0
  v_mov_b32 v20, 1.0
  v_mov_b32 v21, 1.0
  s_mov_b32 s29, 65536
  s_branch L_wf_83
L_w_81:
  s_sleep 1
L_wf_83:
  ds_read_b32 v3, v1 offset:220
  s_waitcnt lgkmcnt(0)
  v_readfirstlane_b32 s40, v3
  s_sub_u32 s29, s29, 1
  s_cbranch_scc1 L_wo_82
  s_cmp_ge_u32 s40, 1
  s_cbranch_scc0 L_w_81
L_wo_82:
  s_setprio 2
  s_mov_b32 s29, 65536
L_pw_84:
  ds_read_b32 v3, v1 offset:220
  ds_read_b64 v[24:25], v16 offset:11264
  s_waitcnt lgkmcnt(0)
  v_readfirstlane_b32 s40, v3
  s_sub_u32 s29, s29, 1
  s_cbranch_scc1 L_pwo_85
  s_and_b32 s41, s40, 0xff
  s_cmp_eq_u32 s41, 0x8
  s_cbranch_scc0 L_pw_84
L_pwo_85:
  s_cmp_eq_u32 s40, 8
  s_cbranch_scc1 L_unitw
  s_mov_b32 s29, 65536
L_w_86:
  ds_read_b32 v3, v1 offset:196
  s_waitcnt lgkmcnt(0)
  v_readfirstlane_b32 s40, v3
  s_sub_u32 s29, s29, 1
  s_cbranch_scc1 L_wo_87
  s_cmp_ge_u32 s40, 8
  s_cbranch_scc0 L_w_86
L_wo_87:
  ds_read_b64 v[20:21], v16 offset:10752
  s_waitcnt lgkmcnt(0)
  v_max_f32 v22, v20, v21
  s_nop 1
  v_max_f32_dpp v22, v22, v22 quad_perm:[1,0,3,2] row_mask:0xf bank_mask:0xf
  s_nop 1
  v_max_f32_dpp v22, v22, v22 quad_perm:[2,3,0,1] row_mask:0xf bank_mask:0xf
  s_nop 1
  v_max_f32_dpp v22, v22, v22 row_half_mirror row_mask:0xf bank_mask:0xf
  s_nop 1
  v_max_f32_dpp v22, v22, v22 row_mirror row_mask:0xf bank_mask:0xf
  v_mov_b32 v23, v22
  s_nop 1
  v_permlane16_swap_b32 v22, v23
  v_max_f32 v22, v22, v23
  v_mov_b32 v23, v22
  s_nop 1
  v_permlane32_swap_b32 v22, v23
  v_max_f32 v22, v22, v23
  v_sub_f32 v20, v20, v22
  v_sub_f32 v21, v21, v22
  v_exp_f32 v20, v20
  v_exp_f32 v21, v21
  s_nop 0
  v_cvt_pk_bf16_f32 v20, v20, v20
  v_and_b32 v20, 0xffff0000, v20
  v_cvt_pk_bf16_f32 v21, v21, v21
  v_and_b32 v21, 0xffff0000, v21
L_unitw:
  v_mul_f32 v24, abs(v24), v20
  v_fma_f32 v24, abs(v25), v21, v24
  s_nop 1
  v_add_f32_dpp v24, v24, v24 quad_perm:[1,0,3,2] row_mask:0xf bank_mask:0xf
  s_nop 1
  v_add_f32_dpp v24, v24, v24 quad_perm:[2,3,0,1] row_mask:0xf bank_mask:0xf
  s_nop 1
  v_add_f32_dpp v24, v24, v24 row_half_mirror row_mask:0xf bank_mask:0xf
  s_nop 1
  v_add_f32_dpp v24, v24, v24 row_mirror row_mask:0xf bank_mask:0xf
  s_nop 1
  v_add_f32_dpp v24, v24, v24 row_bcast:15 row_mask:0xa bank_mask:0xf
  s_nop 1
  v_add_f32_dpp v24, v24, v24 row_bcast:31 row_mask:0xc bank_mask:0xf
  s_nop 1
  v_readlane_b32 s40, v24, 63
  s_nop 1
  v_rcp_f32 v24, s40
  s_nop 0
  ds_write_b32 v1, v24 offset:216
  ds_write_b32 v1, v2 offset:212
  v_mov_b32 v28, v24
  s_waitcnt vmcnt(8)
  v_perm_b32 v64, v34, v32, s100
  v_perm_b32 v68, v34, v32, s101
  v_perm_b32 v72, v35, v33, s100
  v_perm_b32 v76, v35, v33, s101
  v_perm_b32 v65, v42, v40, s100
  v_perm_b32 v69, v42, v40, s101
  v_perm_b32 v73, v43, v41, s100
  v_perm_b32 v77, v43, v41, s101
  v_perm_b32 v66, v38, v36, s100
  v_perm_b32 v70, v38, v36, s101
  v_perm_b32 v74, v39, v37, s100
  v_perm_b32 v78, v39, v37, s101
  v_perm_b32 v67, v46, v44, s100
  v_perm_b32 v71, v46, v44, s101
  v_perm_b32 v75, v47, v45, s100
  v_perm_b32 v79, v47, v45, s101
  s_waitcnt vmcnt(0)
  v_perm_b32 v80, v50, v48, s100
  v_perm_b32 v84, v50, v48, s101
  v_perm_b32 v88, v51, v49, s100
  v_perm_b32 v92, v51, v49, s101
  v_perm_b32 v81, v58, v56, s100
  v_perm_b32 v85, v58, v56, s101
  v_perm_b32 v89, v59, v57, s100
  v_perm_b32 v93, v59, v57, s101
  v_perm_b32 v82, v54, v52, s100
  v_perm_b32 v86, v54, v52, s101
  v_perm_b32 v90, v55, v53, s100
  v_perm_b32 v94, v55, v53, s101
  v_perm_b32 v83, v62, v60, s100
  v_perm_b32 v87, v62, v60, s101
  v_perm_b32 v91, v63, v61, s100
  v_perm_b32 v95, v63, v61, s101
  s_mov_b32 s29, 65536
  s_branch L_wf_90
L_w_88:
  s_sleep 1
L_wf_90:
  ds_read_b32 v3, v1 offset:32
  s_waitcnt lgkmcnt(0)
  v_readfirstlane_b32 s40, v3
  s_sub_u32 s29, s29, 1
  s_cbranch_scc1 L_wo_89
  s_cmp_ge_u32 s40, 8
  s_cbranch_scc0 L_w_88
L_wo_89:
  s_mov_b32 s43, 8192
L_h4_92:
  buffer_load_dwordx4 v[8:11], v29, s[4:7], s61 offen sc1
  buffer_load_dwordx4 v[12:15], v29, s[4:7], s61 offen offset:16 sc1
  s_waitcnt vmcnt(0)
  v_xor_b32 v3, s28, v9
  v_bitop3_b32 v3, v11, s28, v3 bitop3:0xbe
  v_bitop3_b32 v3, v13, s28, v3 bitop3:0xbe
  v_bitop3_b32 v3, v15, s28, v3 bitop3:0xbe
  v_cmp_ne_u32 vcc, 0, v3
  s_cbranch_vccz L_h4o_93
  s_mov_b64 exec, vcc
  s_sub_u32 s43, s43, 1
  s_cbranch_scc0 L_h4_92
L_h4o_93:
  s_mov_b64 exec, -1
  v_mov_b32 v9, v12
  v_mov_b32 v11, v14
  s_nop 1
  v_mfma_f32_16x16x32_bf16 v[96:99], v[8:11], v[64:67], 0
  v_mfma_f32_16x16x32_bf16 v[100:103], v[8:11], v[68:71], 0
  v_mfma_f32_16x16x32_bf16 v[104:107], v[8:11], v[72:75], 0
  v_mfma_f32_16x16x32_bf16 v[108:111], v[8:11], v[76:79], 0
  v_mfma_f32_16x16x32_bf16 v[112:115], v[8:11], v[80:83], 0
  v_mfma_f32_16x16x32_bf16 v[116:119], v[8:11], v[84:87], 0
  v_mfma_f32_16x16x32_bf16 v[120:123], v[8:11], v[88:91], 0
  v_mfma_f32_16x16x32_bf16 v[124:127], v[8:11], v[92:95], 0
  s_nop 0
  v_pk_add_f32 v[96:97], v[96:97], v[98:99]
  v_pk_add_f32 v[100:101], v[100:101], v[102:103]
  v_pk_add_f32 v[104:105], v[104:105], v[106:107]
  v_pk_add_f32 v[108:109], v[108:109], v[110:111]
  v_add_f32 v16, v96, v97
  v_add_f32 v17, v100, v101
  v_add_f32 v18, v104, v105
  v_add_f32 v19, v108, v109
  v_mov_b32 v20, v16
  v_mov_b32 v21, v17
  v_mov_b32 v22, v18
  v_mov_b32 v23, v19
  s_add_u32 s51, s50, 0
  v_permlane16_swap_b32 v16, v20
  v_permlane16_swap_b32 v17, v21
  v_permlane16_swap_b32 v18, v22
  v_permlane16_swap_b32 v19, v23
  v_pk_add_f32 v[16:17], v[16:17], v[20:21]
  v_pk_add_f32 v[18:19], v[18:19], v[22:23]
  v_mul_f32 v96, v16, v28
  v_mul_f32 v97, v17, v28
  v_mul_f32 v98, v18, v28
  v_mul_f32 v99, v19, v28
  v_bfi_b32 v96, v31, s66, v96
  v_bfi_b32 v97, v31, s67, v97
  v_bfi_b32 v98, v31, s68, v98
  v_bfi_b32 v99, v31, s69, v99
  s_mov_b64 exec, 0xffff
  buffer_store_dwordx4 v[96:99], v30, s[4:7], s51 offen sc1
  s_mov_b64 exec, -1
  v_pk_add_f32 v[112:113], v[112:113], v[114:115]
  v_pk_add_f32 v[116:117], v[116:117], v[118:119]
  v_pk_add_f32 v[120:121], v[120:121], v[122:123]
  v_pk_add_f32 v[124:125], v[124:125], v[126:127]
  v_add_f32 v16, v112, v113
  v_add_f32 v17, v116, v117
  v_add_f32 v18, v120, v121
  v_add_f32 v19, v124, v125
  v_mov_b32 v20, v16
  v_mov_b32 v21, v17
  v_mov_b32 v22, v18
  v_mov_b32 v23, v19
  s_add_u32 s51, s50, 32768
  v_permlane16_swap_b32 v16, v20
  v_permlane16_swap_b32 v17, v21
  v_permlane16_swap_b32 v18, v22
  v_permlane16_swap_b32 v19, v23
  v_pk_add_f32 v[16:17], v[16:17], v[20:21]
  v_pk_add_f32 v[18:19], v[18:19], v[22:23]
  v_mul_f32 v112, v16, v28
  v_mul_f32 v113, v17, v28
  v_mul_f32 v114, v18, v28
  v_mul_f32 v115, v19, v28
  v_bfi_b32 v112, v31, s66, v112
  v_bfi_b32 v113, v31, s67, v113
  v_bfi_b32 v114, v31, s68, v114
  v_bfi_b32 v115, v31, s69, v115
  s_mov_b64 exec, 0xffff
  buffer_store_dwordx4 v[112:115], v30, s[4:7], s51 offen sc1
  s_mov_b64 exec, -1
  s_mov_b64 exec, 1
  ds_add_u32 v1, v2 offset:56
  s_mov_b64 exec, -1
  s_branch L_G_end
L_G_uv10:
L_G_uv9:
  v_lshlrev_b32 v7, 13, v5
  v_lshl_add_u32 v7, v4, 3, v7
  s_lshl_b32 s56, s15, 17
  s_lshl_b32 s41, s14, 8
  s_add_u32 s56, s56, s41
  s_sub_u32 s52, s3, 9
  s_lshl_b32 s41, s52, 7
  s_add_u32 s56, s56, s41
  s_add_u32 s57, s56, 32768
  s_mov_b32 s8, s24
  s_mov_b32 s9, s25
  s_mov_b32 s10, 4194304
  s_mov_b32 s11, 0x20000
  s_waitcnt vmcnt(31)
  buffer_load_dwordx2 v[32:33], v7, s[8:11], s56 offen nt
  s_add_u32 s42, s56, 1048576
  s_waitcnt vmcnt(31)
  buffer_load_dwordx2 v[34:35], v7, s[8:11], s42 offen nt
  s_add_u32 s42, s56, 2097152
  s_waitcnt vmcnt(31)
  buffer_load_dwordx2 v[36:37], v7, s[8:11], s42 offen nt
  s_add_u32 s42, s56, 3145728
  s_waitcnt vmcnt(31)
  buffer_load_dwordx2 v[38:39], v7, s[8:11], s42 offen nt
  s_add_u32 s42, s56, 65536
  s_waitcnt vmcnt(31)
  buffer_load_dwordx2 v[40:41], v7, s[8:11], s42 offen nt
  s_add_u32 s42, s56, 1114112
  s_waitcnt vmcnt(31)
  buffer_load_dwordx2 v[42:43], v7, s[8:11], s42 offen nt
  s_add_u32 s42, s56, 2162688
  s_waitcnt vmcnt(31)
  buffer_load_dwordx2 v[44:45], v7, s[8:11], s42 offen nt
  s_add_u32 s42, s56, 3211264
  s_waitcnt vmcnt(31)
  buffer_load_dwordx2 v[46:47], v7, s[8:11], s42 offen nt
  s_waitcnt vmcnt(31)
  buffer_load_dwordx2 v[48:49], v7, s[8:11], s57 offen nt
  s_add_u32 s42, s57, 1048576
  s_waitcnt vmcnt(31)
  buffer_load_dwordx2 v[50:51], v7, s[8:11], s42 offen nt
  s_add_u32 s42, s57, 2097152
  s_waitcnt vmcnt(31)
  buffer_load_dwordx2 v[52:53], v7, s[8:11], s42 offen nt
  s_add_u32 s42, s57, 3145728
  s_waitcnt vmcnt(31)
  buffer_load_dwordx2 v[54:55], v7, s[8:11], s42 offen nt
  s_add_u32 s42, s57, 65536
  s_waitcnt vmcnt(31)
  buffer_load_dwordx2 v[56:57], v7, s[8:11], s42 offen nt
  s_add_u32 s42, s57, 1114112
  s_waitcnt vmcnt(31)
  buffer_load_dwordx2 v[58:59], v7, s[8:11], s42 offen nt
  s_add_u32 s42, s57, 2162688
  s_waitcnt vmcnt(31)
  buffer_load_dwordx2 v[60:61], v7, s[8:11], s42 offen nt
  s_add_u32 s42, s57, 3211264
  s_waitcnt vmcnt(31)
  buffer_load_dwordx2 v[62:63], v7, s[8:11], s42 offen nt
L_G_uv:
  v_mul_u32_u24 v6, 10240, v5
  v_lshl_add_u32 v6, v4, 3, v6
  s_lshl_b32 s40, s14, 7
  s_lshr_b32 s41, s15, 1
  s_lshl_b32 s41, s41, 5
  s_add_u32 s40, s40, s41
  s_mul_i32 s40, s40, 1280
  s_and_b32 s41, s15, 1
  s_mul_i32 s41, s41, 640
  s_add_u32 s48, s40, s41
  s_mov_b32 s44, s26
  s_mov_b32 s45, s27
  s_mov_b32 s46, 5242880
  s_mov_b32 s47, 0x20000
  v_and_b32 v31, 7, v4
  v_lshlrev_b32 v29, 7, v31
  v_lshl_add_u32 v29, v5, 5, v29
  s_lshl_b32 s50, s14, 2
  s_lshr_b32 s51, s15, 1
  s_add_u32 s50, s50, s51
  s_lshl_b32 s61, s50, 10
  s_add_u32 s61, s61, 659456
  v_lshrrev_b32 v30, 3, v4
  v_lshlrev_b32 v30, 14, v30
  v_lshl_add_u32 v30, v31, 4, v30
  v_mov_b32 v31, 0xff
  s_and_b32 s41, s15, 1
  s_mul_i32 s41, s41, 163840
  s_lshl_b32 s50, s50, 7
  s_add_u32 s50, s50, s41
  s_add_u32 s50, s50, 937984
  s_and_b32 s66, s28, 1
  s_mul_i32 s66, s66, 0x01010101
  s_and_b32 s67, s28, 0xfefefefe
  s_or_b32 s66, s66, s67
  s_bfe_u32 s67, s66, 0x80008
  s_bfe_u32 s68, s66, 0x80010
  s_lshr_b32 s69, s66, 24
  s_and_b32 s66, s66, 0xff
  s_add_u32 s49, s52, 2
  s_mul_i32 s53, s49, 32768
  s_add_u32 s50, s50, s53
  s_lshl_b32 s49, s49, 7
  s_add_u32 s49, s49, s48
  v_and_b32 v7, 7, v4
  v_mul_u32_u24 v8, 144, v4
  v_lshl_add_u32 v8, v5, 4, v8
  v_lshlrev_b32 v9, 4, v0
  v_lshrrev_b32 v11, 3, v4
  v_lshlrev_b32 v11, 10, v11
  v_lshl_add_u32 v11, v7, 4, v11
  s_lshl_b32 s40, s14, 2
  s_lshl_b32 s41, s52, 1
  s_add_u32 s40, s40, s41
  s_lshl_b32 s40, s40, 3
  s_add_u32 s40, s40, s15
  s_lshl_b32 s40, s40, 7
  s_add_u32 s54, s40, 659456
  s_waitcnt vmcnt(31)
  buffer_load_dwordx2 v[64:65], v6, s[44:47], s49 offen nt
  s_waitcnt vmcnt(31)
  buffer_load_dwordx2 v[66:67], v6, s[44:47], s49 offen offset:1280 nt
  s_waitcnt vmcnt(31)
  buffer_load_dwordx2 v[68:69], v6, s[44:47], s49 offen offset:2560 nt
  s_waitcnt vmcnt(31)
  buffer_load_dwordx2 v[70:71], v6, s[44:47], s49 offen offset:3840 nt
  s_add_u32 s42, s49, 5120
  s_waitcnt vmcnt(31)
  buffer_load_dwordx2 v[72:73], v6, s[44:47], s42 offen nt
  s_waitcnt vmcnt(31)
  buffer_load_dwordx2 v[74:75], v6, s[44:47], s42 offen offset:1280 nt
  s_waitcnt vmcnt(31)
  buffer_load_dwordx2 v[76:77], v6, s[44:47], s42 offen offset:2560 nt
  s_waitcnt vmcnt(31)
  buffer_load_dwordx2 v[78:79], v6, s[44:47], s42 offen offset:3840 nt
  buffer_load_dwordx4 v[16:19], v29, s[4:7], s61 offen sc1
  s_add_u32 s51, s50, 0
  buffer_load_dwordx4 v[20:23], v30, s[4:7], s51 offen sc1
  s_cmp_eq_u32 s3, 9
  s_cbranch_scc0 L_nohd
  s_and_b32 s56, s13, 1
  s_lshl_b32 s56, s56, 7
  s_add_u32 s56, s56, s12
  s_lshl_b32 s56, s56, 4
  s_lshr_b32 s57, s13, 1
  s_add_u32 s56, s56, s57
  s_lshl_b32 s56, s56, 3
  s_add_u32 s56, s56, 528384
  s_add_u32 s57, s56, 32768
  v_lshlrev_b32 v15, 10, v4
  v_lshl_add_u32 v27, v5, 15, v15
  v_mov_b32 v24, 0
  v_mov_b32 v25, s28
  v_mov_b32 v12, 0
  v_mov_b32 v14, 0
  v_mov_b32 v26, v11
  s_mov_b32 s58, 0x3f803f80
  s_mov_b32 s29, 65536
L_pw_94:
  s_cmp_lg_u32 s29, 65472
  s_cbranch_scc1 L_wd_96
  buffer_store_dwordx4 v[148:151], v152, s[4:7], s70 offen sc1
  L_wd_96:
  s_sleep 1
  ds_read_b32 v3, v1 offset:236
  s_waitcnt lgkmcnt(0)
  v_readfirstlane_b32 s40, v3
  s_sub_u32 s29, s29, 1
  s_cbranch_scc1 L_pwo_95
  s_and_b32 s41, s40, 0xfff
  s_cmp_eq_u32 s41, 0x222
  s_cbranch_scc0 L_pw_94
L_pwo_95:
  s_setprio 1
  s_mov_b32 s29, 65536
L_pw_97:
  ds_read_b32 v3, v1 offset:236
  s_waitcnt lgkmcnt(0)
  v_readfirstlane_b32 s40, v3
  s_sub_u32 s29, s29, 1
  s_cbranch_scc1 L_pwo_98
  s_and_b32 s41, s40, 0xffff
  s_cmp_eq_u32 s41, 0x2222
  s_cbranch_scc0 L_pw_97
L_pwo_98:
  s_cmp_lg_u32 s40, 0x2222
  s_cbranch_scc1 L_nohd2
  ds_read_b128 v[128:131], v9 offset:4096
  ds_read_b128 v[132:135], v9 offset:5120
  ds_read_b128 v[136:139], v9 offset:6144
  ds_read_b128 v[140:143], v9 offset:7168
  s_waitcnt lgkmcnt(3)
  v_dot2c_f32_bf16 v12, s58, v128
  v_dot2c_f32_bf16 v14, s58, v129
  v_dot2c_f32_bf16 v12, s58, v130
  v_dot2c_f32_bf16 v14, s58, v131
  s_waitcnt lgkmcnt(2)
  v_dot2c_f32_bf16 v12, s58, v132
  v_dot2c_f32_bf16 v14, s58, v133
  v_dot2c_f32_bf16 v12, s58, v134
  v_dot2c_f32_bf16 v14, s58, v135
  s_waitcnt lgkmcnt(1)
  v_dot2c_f32_bf16 v12, s58, v136
  v_dot2c_f32_bf16 v14, s58, v137
  v_dot2c_f32_bf16 v12, s58, v138
  v_dot2c_f32_bf16 v14, s58, v139
  s_waitcnt lgkmcnt(0)
  v_dot2c_f32_bf16 v12, s58, v140
  v_dot2c_f32_bf16 v14, s58, v141
  v_dot2c_f32_bf16 v12, s58, v142
  v_dot2c_f32_bf16 v14, s58, v143
  v_mov_b32 v13, s28
  v_mov_b32 v11, s28
  s_nop 0
  v_add_f32 v12, v12, v14
  v_mov_b32 v14, v12
  s_nop 1
  v_permlane16_swap_b32 v12, v14
  v_add_f32 v12, v12, v14
  v_mov_b32 v14, v12
  s_nop 1
  v_permlane32_swap_b32 v12, v14
  v_add_f32 v12, v12, v14
  s_mov_b32 s29, 65536
L_w_99:
  ds_read_b32 v3, v1 offset:192
  s_waitcnt lgkmcnt(0)
  v_readfirstlane_b32 s40, v3
  s_sub_u32 s29, s29, 1
  s_cbranch_scc1 L_wo_100
  s_cmp_ge_u32 s40, 4
  s_cbranch_scc0 L_w_99
L_wo_100:
  s_mov_b64 exec, 0xffff
  buffer_store_dwordx2 v[12:13], v27, s[4:7], s57 offen sc1
  s_mov_b64 exec, -1
  s_mov_b64 exec, 0xffff
  buffer_store_dwordx2 v[24:25], v15, s[4:7], s56 offen sc1
  s_mov_b64 exec, -1
L_nohd2:
  v_mov_b32 v11, v26
  s_setprio 0
  s_waitcnt vmcnt(2)
  s_cmp_eq_u32 s3, 9
  s_cbranch_scc0 L_qf_101
  buffer_store_dwordx4 v[148:151], v152, s[4:7], s70 offen sc1
  buffer_store_dwordx4 v[148:151], v152, s[4:7], s71 offen sc1
  L_qf_101:
L_nohd:
  s_waitcnt vmcnt(18)
  v_perm_b32 v80, v34, v32, s100
  v_perm_b32 v84, v34, v32, s101
  v_perm_b32 v88, v35, v33, s100
  v_perm_b32 v92, v35, v33, s101
  v_perm_b32 v81, v38, v36, s100
  v_perm_b32 v85, v38, v36, s101
  v_perm_b32 v89, v39, v37, s100
  v_perm_b32 v93, v39, v37, s101
  v_perm_b32 v82, v42, v40, s100
  v_perm_b32 v86, v42, v40, s101
  v_perm_b32 v90, v43, v41, s100
  v_perm_b32 v94, v43, v41, s101
  v_perm_b32 v83, v46, v44, s100
  v_perm_b32 v87, v46, v44, s101
  v_perm_b32 v91, v47, v45, s100
  v_perm_b32 v95, v47, v45, s101
  s_waitcnt vmcnt(10)
  v_perm_b32 v96, v50, v48, s100
  v_perm_b32 v100, v50, v48, s101
  v_perm_b32 v104, v51, v49, s100
  v_perm_b32 v108, v51, v49, s101
  v_perm_b32 v97, v54, v52, s100
  v_perm_b32 v101, v54, v52, s101
  v_perm_b32 v105, v55, v53, s100
  v_perm_b32 v109, v55, v53, s101
  v_perm_b32 v98, v58, v56, s100
  v_perm_b32 v102, v58, v56, s101
  v_perm_b32 v106, v59, v57, s100
  v_perm_b32 v110, v59, v57, s101
  v_perm_b32 v99, v62, v60, s100
  v_perm_b32 v103, v62, v60, s101
  v_perm_b32 v107, v63, v61, s100
  v_perm_b32 v111, v63, v61, s101
  v_mov_b32 v61, s28
  v_mov_b32 v63, s28
  s_waitcnt vmcnt(0)
  v_perm_b32 v112, v66, v64, s100
  v_perm_b32 v116, v66, v64, s101
  v_perm_b32 v120, v67, v65, s100
  v_perm_b32 v124, v67, v65, s101
  v_perm_b32 v113, v74, v72, s100
  v_perm_b32 v117, v74, v72, s101
  v_perm_b32 v121, v75, v73, s100
  v_perm_b32 v125, v75, v73, s101
  v_perm_b32 v114, v70, v68, s100
  v_perm_b32 v118, v70, v68, s101
  v_perm_b32 v122, v71, v69, s100
  v_perm_b32 v126, v71, v69, s101
  v_perm_b32 v115, v78, v76, s100
  v_perm_b32 v119, v78, v76, s101
  v_perm_b32 v123, v79, v77, s100
  v_perm_b32 v127, v79, v77, s101
  s_mov_b32 s29, 65536
L_pw_103:
  s_cmp_lg_u32 s29, 65488
  s_cbranch_scc1 L_wd_105
  s_cmp_eq_u32 s3, 9
  s_cbranch_scc0 L_qf_102
  buffer_store_dwordx4 v[148:151], v152, s[4:7], s70 offen sc1
  L_qf_102:
  L_wd_105:
  s_sleep 2
  ds_read_b32 v3, v1 offset:220
  s_waitcnt lgkmcnt(0)
  v_readfirstlane_b32 s40, v3
  s_sub_u32 s29, s29, 1
  s_cbranch_scc1 L_pwo_104
  s_and_b32 s41, s40, 0xff
  s_cmp_eq_u32 s41, 0x8
  s_cbranch_scc0 L_pw_103
L_pwo_104:
  s_setprio 3
  s_mov_b32 s29, 65536
L_w_106:
  ds_read_b32 v3, v1 offset:32
  ds_read_b128 v[32:35], v8 offset:8192
  ds_read_b128 v[36:39], v8 offset:8256
  s_waitcnt lgkmcnt(0)
  v_readfirstlane_b32 s40, v3
  s_sub_u32 s29, s29, 1
  s_cbranch_scc1 L_wo_107
  s_cmp_ge_u32 s40, 8
  s_cbranch_scc0 L_w_106
L_wo_107:
  s_waitcnt lgkmcnt(1)
  v_mfma_f32_16x16x32_bf16 v[128:131], v[32:35], v[80:83], 0
  v_mfma_f32_16x16x32_bf16 v[132:135], v[32:35], v[84:87], 0
  v_mfma_f32_16x16x32_bf16 v[136:139], v[32:35], v[88:91], 0
  v_mfma_f32_16x16x32_bf16 v[140:143], v[32:35], v[92:95], 0
  s_waitcnt lgkmcnt(0)
  v_mfma_f32_16x16x32_bf16 v[128:131], v[36:39], v[96:99], v[128:131]
  v_mfma_f32_16x16x32_bf16 v[132:135], v[36:39], v[100:103], v[132:135]
  v_mfma_f32_16x16x32_bf16 v[136:139], v[36:39], v[104:107], v[136:139]
  v_mfma_f32_16x16x32_bf16 v[140:143], v[36:39], v[108:111], v[140:143]
  s_nop 4
  v_pk_add_f32 v[128:129], v[128:129], v[130:131]
  v_pk_add_f32 v[132:133], v[132:133], v[134:135]
  v_pk_add_f32 v[136:137], v[136:137], v[138:139]
  v_pk_add_f32 v[140:141], v[140:141], v[142:143]
  v_add_f32 v16, v128, v129
  v_add_f32 v17, v132, v133
  v_add_f32 v18, v136, v137
  v_add_f32 v19, v140, v141
  s_nop 0
  v_permlane32_swap_b32 v16, v18
  v_permlane32_swap_b32 v17, v19
  v_pk_add_f32 v[16:17], v[16:17], v[18:19]
  v_mov_b32 v18, v16
  v_mov_b32 v19, v17
  s_nop 0
  v_permlane16_swap_b32 v16, v18
  v_permlane16_swap_b32 v17, v19
  v_pk_add_f32 v[16:17], v[16:17], v[18:19]
  v_cvt_pk_bf16_f32 v60, v16, v17
  v_mov_b32 v62, v60
  s_nop 1
  v_permlane32_swap_b32 v60, v62
  s_mov_b64 exec, 0xffff
  buffer_store_dwordx4 v[60:63], v11, s[4:7], s54 offen
  s_mov_b64 exec, -1
  s_mov_b32 s29, 65536
L_w_108:
  ds_read_b32 v3, v1 offset:212
  ds_read_b32 v28, v1 offset:216
  s_waitcnt lgkmcnt(0)
  v_readfirstlane_b32 s40, v3
  s_sub_u32 s29, s29, 1
  s_cbranch_scc1 L_wo_109
  s_cmp_ge_u32 s40, 1
  s_cbranch_scc0 L_w_108
L_wo_109:
  s_mov_b32 s43, 8192
L_h4_111:
  buffer_load_dwordx4 v[32:35], v29, s[4:7], s61 offen sc1
  buffer_load_dwordx4 v[36:39], v29, s[4:7], s61 offen offset:16 sc1
  s_waitcnt vmcnt(0)
  v_xor_b32 v3, s28, v33
  v_bitop3_b32 v3, v35, s28, v3 bitop3:0xbe
  v_bitop3_b32 v3, v37, s28, v3 bitop3:0xbe
  v_bitop3_b32 v3, v39, s28, v3 bitop3:0xbe
  v_cmp_ne_u32 vcc, 0, v3
  s_cbranch_vccz L_h4o_112
  s_cmp_lg_u32 s43, 8160
  s_cbranch_scc1 L_h4s_110
  s_mov_b64 exec, 0xffff
  buffer_store_dwordx4 v[60:63], v11, s[4:7], s54 offen sc1
  L_h4s_110:
  s_mov_b64 exec, vcc
  s_sub_u32 s43, s43, 1
  s_cbranch_scc0 L_h4_111
L_h4o_112:
  s_mov_b64 exec, -1
  v_mov_b32 v33, v36
  v_mov_b32 v35, v38
  s_nop 1
  v_mfma_f32_16x16x32_bf16 v[128:131], v[32:35], v[112:115], 0
  v_mfma_f32_16x16x32_bf16 v[132:135], v[32:35], v[116:119], 0
  v_mfma_f32_16x16x32_bf16 v[136:139], v[32:35], v[120:123], 0
  v_mfma_f32_16x16x32_bf16 v[140:143], v[32:35], v[124:127], 0
  s_nop 4
  v_pk_add_f32 v[128:129], v[128:129], v[130:131]
  v_pk_add_f32 v[132:133], v[132:133], v[134:135]
  v_pk_add_f32 v[136:137], v[136:137], v[138:139]
  v_pk_add_f32 v[140:141], v[140:141], v[142:143]
  v_add_f32 v16, v128, v129
  v_add_f32 v17, v132, v133
  v_add_f32 v18, v136, v137
  v_add_f32 v19, v140, v141
  v_mov_b32 v20, v16
  v_mov_b32 v21, v17
  v_mov_b32 v22, v18
  v_mov_b32 v23, v19
  s_add_u32 s51, s50, 0
  v_permlane16_swap_b32 v16, v20
  v_permlane16_swap_b32 v17, v21
  v_permlane16_swap_b32 v18, v22
  v_permlane16_swap_b32 v19, v23
  v_pk_add_f32 v[16:17], v[16:17], v[20:21]
  v_pk_add_f32 v[18:19], v[18:19], v[22:23]
  v_mul_f32 v128, v16, v28
  v_mul_f32 v129, v17, v28
  v_mul_f32 v130, v18, v28
  v_mul_f32 v131, v19, v28
  v_bfi_b32 v128, v31, s66, v128
  v_bfi_b32 v129, v31, s67, v129
  v_bfi_b32 v130, v31, s68, v130
  v_bfi_b32 v131, v31, s69, v131
  s_mov_b64 exec, 0xffff
  buffer_store_dwordx4 v[128:131], v30, s[4:7], s51 offen sc1
  s_mov_b64 exec, -1
  s_mov_b64 exec, 1
  ds_add_u32 v1, v2 offset:56
  s_mov_b64 exec, -1
  s_mov_b64 exec, 0xffff
  buffer_store_dwordx4 v[60:63], v11, s[4:7], s54 offen sc1
  s_mov_b64 exec, -1
  s_branch L_G_end
L_FFNb:
  s_lshr_b32 s40, s13, 3
  s_lshl_b32 s40, s40, 1
  s_and_b32 s41, s15, 1
  s_add_u32 s40, s40, s41
  s_lshl_b32 s40, s40, 3
  s_add_u32 s62, s40, s12
  s_lshr_b32 s63, s15, 1
  v_and_b32 v31, 1, v5
  v_cmp_eq_u32 s[56:57], 1, v31
  s_cmp_lt_u32 s62, 27
  s_cbranch_scc0 L_FFN2
  v_mul_u32_u24 v28, 27648, v5
  v_lshl_add_u32 v28, v4, 3, v28
  v_lshlrev_b32 v7, 4, v5
  s_mul_i32 s58, s63, 320
  v_add_u32 v7, s58, v7
  s_mul_i32 s58, s63, 552960
  s_lshl_b32 s41, s62, 7
  s_add_u32 s58, s58, s41
  s_mov_b32 s8, s30
  s_mov_b32 s9, s31
  s_mov_b32 s10, 2211840
  s_mov_b32 s11, 0x20000
  s_waitcnt vmcnt(31)
  buffer_load_dwordx2 v[48:49], v28, s[8:11], s58 offen nt
  s_waitcnt vmcnt(31)
  buffer_load_dwordx2 v[50:51], v28, s[8:11], s58 offen offset:3456 nt
  s_add_u32 s42, s58, 6912
  s_waitcnt vmcnt(31)
  buffer_load_dwordx2 v[52:53], v28, s[8:11], s42 offen nt
  s_waitcnt vmcnt(31)
  buffer_load_dwordx2 v[54:55], v28, s[8:11], s42 offen offset:3456 nt
  s_add_u32 s42, s58, 13824
  s_waitcnt vmcnt(31)
  buffer_load_dwordx2 v[56:57], v28, s[8:11], s42 offen nt
  s_waitcnt vmcnt(31)
  buffer_load_dwordx2 v[58:59], v28, s[8:11], s42 offen offset:3456 nt
  s_add_u32 s42, s58, 20736
  s_waitcnt vmcnt(31)
  buffer_load_dwordx2 v[60:61], v28, s[8:11], s42 offen nt
  s_waitcnt vmcnt(31)
  buffer_load_dwordx2 v[62:63], v28, s[8:11], s42 offen offset:3456 nt
  s_add_u32 s58, s58, 110592
  s_waitcnt vmcnt(31)
  buffer_load_dwordx2 v[64:65], v28, s[8:11], s58 offen nt
  s_waitcnt vmcnt(31)
  buffer_load_dwordx2 v[66:67], v28, s[8:11], s58 offen offset:3456 nt
  s_add_u32 s42, s58, 6912
  s_waitcnt vmcnt(31)
  buffer_load_dwordx2 v[68:69], v28, s[8:11], s42 offen nt
  s_waitcnt vmcnt(31)
  buffer_load_dwordx2 v[70:71], v28, s[8:11], s42 offen offset:3456 nt
  s_add_u32 s42, s58, 13824
  s_waitcnt vmcnt(31)
  buffer_load_dwordx2 v[72:73], v28, s[8:11], s42 offen nt
  s_waitcnt vmcnt(31)
  buffer_load_dwordx2 v[74:75], v28, s[8:11], s42 offen offset:3456 nt
  s_add_u32 s42, s58, 20736
  s_waitcnt vmcnt(31)
  buffer_load_dwordx2 v[76:77], v28, s[8:11], s42 offen nt
  s_waitcnt vmcnt(31)
  buffer_load_dwordx2 v[78:79], v28, s[8:11], s42 offen offset:3456 nt
  s_add_u32 s58, s58, 110592
  s_waitcnt vmcnt(31)
  buffer_load_dwordx2 v[80:81], v28, s[8:11], s58 offen nt
  s_waitcnt vmcnt(31)
  buffer_load_dwordx2 v[82:83], v28, s[8:11], s58 offen offset:3456 nt
  s_add_u32 s42, s58, 6912
  s_waitcnt vmcnt(31)
  buffer_load_dwordx2 v[84:85], v28, s[8:11], s42 offen nt
  s_waitcnt vmcnt(31)
  buffer_load_dwordx2 v[86:87], v28, s[8:11], s42 offen offset:3456 nt
  s_add_u32 s42, s58, 13824
  s_waitcnt vmcnt(31)
  buffer_load_dwordx2 v[88:89], v28, s[8:11], s42 offen nt
  s_waitcnt vmcnt(31)
  buffer_load_dwordx2 v[90:91], v28, s[8:11], s42 offen offset:3456 nt
  s_add_u32 s42, s58, 20736
  s_waitcnt vmcnt(31)
  buffer_load_dwordx2 v[92:93], v28, s[8:11], s42 offen nt
  s_waitcnt vmcnt(31)
  buffer_load_dwordx2 v[94:95], v28, s[8:11], s42 offen offset:3456 nt
  s_add_u32 s58, s58, 110592
  s_waitcnt vmcnt(31)
  buffer_load_dwordx2 v[96:97], v28, s[8:11], s58 offen nt
  s_waitcnt vmcnt(31)
  buffer_load_dwordx2 v[98:99], v28, s[8:11], s58 offen offset:3456 nt
  s_add_u32 s42, s58, 6912
  s_waitcnt vmcnt(31)
  buffer_load_dwordx2 v[100:101], v28, s[8:11], s42 offen nt
  s_waitcnt vmcnt(31)
  buffer_load_dwordx2 v[102:103], v28, s[8:11], s42 offen offset:3456 nt
  s_add_u32 s42, s58, 13824
  s_waitcnt vmcnt(31)
  buffer_load_dwordx2 v[104:105], v28, s[8:11], s42 offen nt
  s_waitcnt vmcnt(31)
  buffer_load_dwordx2 v[106:107], v28, s[8:11], s42 offen offset:3456 nt
  s_add_u32 s42, s58, 20736
  s_waitcnt vmcnt(31)
  buffer_load_dwordx2 v[108:109], v28, s[8:11], s42 offen nt
  s_waitcnt vmcnt(31)
  buffer_load_dwordx2 v[110:111], v28, s[8:11], s42 offen offset:3456 nt
  s_add_u32 s58, s58, 110592
  s_waitcnt vmcnt(31)
  buffer_load_dwordx2 v[112:113], v28, s[8:11], s58 offen nt
  s_waitcnt vmcnt(31)
  buffer_load_dwordx2 v[114:115], v28, s[8:11], s58 offen offset:3456 nt
  s_add_u32 s42, s58, 6912
  s_waitcnt vmcnt(31)
  buffer_load_dwordx2 v[116:117], v28, s[8:11], s42 offen nt
  s_waitcnt vmcnt(31)
  buffer_load_dwordx2 v[118:119], v28, s[8:11], s42 offen offset:3456 nt
  s_add_u32 s42, s58, 13824
  s_waitcnt vmcnt(31)
  buffer_load_dwordx2 v[120:121], v28, s[8:11], s42 offen nt
  s_waitcnt vmcnt(31)
  buffer_load_dwordx2 v[122:123], v28, s[8:11], s42 offen offset:3456 nt
  s_add_u32 s42, s58, 20736
  s_waitcnt vmcnt(31)
  buffer_load_dwordx2 v[124:125], v28, s[8:11], s42 offen nt
  s_waitcnt vmcnt(31)
  buffer_load_dwordx2 v[126:127], v28, s[8:11], s42 offen offset:3456 nt
  s_mov_b32 s29, 65536
L_w_113:
  ds_read_b32 v3, v1 offset:44
  ds_read_b32 v6, v1 offset:40
  s_waitcnt lgkmcnt(0)
  v_readfirstlane_b32 s28, v3
  s_sub_u32 s29, s29, 1
  s_cbranch_scc1 L_wo_114
  s_cmp_ge_u32 s28, 1
  s_cbranch_scc0 L_w_113
L_wo_114:
  v_readfirstlane_b32 s28, v6
  s_mov_b32 s29, 65536
L_w_115:
  ds_read_b32 v3, v1 offset:204
  s_waitcnt lgkmcnt(0)
  v_readfirstlane_b32 s40, v3
  s_sub_u32 s29, s29, 1
  s_cbranch_scc1 L_wo_116
  s_cmp_ge_u32 s40, 1
  s_cbranch_scc0 L_w_115
L_wo_116:
  ds_read_b128 v[8:11], v7 offset:12288
  ds_read_b128 v[12:15], v7 offset:12352
  ds_read_b128 v[16:19], v7 offset:12416
  ds_read_b128 v[20:23], v7 offset:12480
  ds_read_b128 v[24:27], v7 offset:12544
  s_waitcnt lgkmcnt(0)
  s_waitcnt vmcnt(32)
  v_perm_b32 v32, v50, v48, s100
  v_perm_b32 v36, v50, v48, s101
  v_perm_b32 v40, v51, v49, s100
  v_perm_b32 v44, v51, v49, s101
  v_perm_b32 v33, v54, v52, s100
  v_perm_b32 v37, v54, v52, s101
  v_perm_b32 v41, v55, v53, s100
  v_perm_b32 v45, v55, v53, s101
  v_perm_b32 v34, v58, v56, s100
  v_perm_b32 v38, v58, v56, s101
  v_perm_b32 v42, v59, v57, s100
  v_perm_b32 v46, v59, v57, s101
  v_perm_b32 v35, v62, v60, s100
  v_perm_b32 v39, v62, v60, s101
  v_perm_b32 v43, v63, v61, s100
  v_perm_b32 v47, v63, v61, s101
  s_nop 1
  v_mfma_f32_16x16x32_bf16 v[144:147], v[8:11], v[32:35], 0
  v_mfma_f32_16x16x32_bf16 v[148:151], v[8:11], v[36:39], 0
  v_mfma_f32_16x16x32_bf16 v[152:155], v[8:11], v[40:43], 0
  v_mfma_f32_16x16x32_bf16 v[156:159], v[8:11], v[44:47], 0
  s_waitcnt vmcnt(24)
  v_perm_b32 v48, v66, v64, s100
  v_perm_b32 v52, v66, v64, s101
  v_perm_b32 v56, v67, v65, s100
  v_perm_b32 v60, v67, v65, s101
  v_perm_b32 v49, v70, v68, s100
  v_perm_b32 v53, v70, v68, s101
  v_perm_b32 v57, v71, v69, s100
  v_perm_b32 v61, v71, v69, s101
  v_perm_b32 v50, v74, v72, s100
  v_perm_b32 v54, v74, v72, s101
  v_perm_b32 v58, v75, v73, s100
  v_perm_b32 v62, v75, v73, s101
  v_perm_b32 v51, v78, v76, s100
  v_perm_b32 v55, v78, v76, s101
  v_perm_b32 v59, v79, v77, s100
  v_perm_b32 v63, v79, v77, s101
  s_nop 1
  v_mfma_f32_16x16x32_bf16 v[144:147], v[12:15], v[48:51], v[144:147]
  v_mfma_f32_16x16x32_bf16 v[148:151], v[12:15], v[52:55], v[148:151]
  v_mfma_f32_16x16x32_bf16 v[152:155], v[12:15], v[56:59], v[152:155]
  v_mfma_f32_16x16x32_bf16 v[156:159], v[12:15], v[60:63], v[156:159]
  s_waitcnt vmcnt(16)
  v_perm_b32 v64, v82, v80, s100
  v_perm_b32 v68, v82, v80, s101
  v_perm_b32 v72, v83, v81, s100
  v_perm_b32 v76, v83, v81, s101
  v_perm_b32 v65, v86, v84, s100
  v_perm_b32 v69, v86, v84, s101
  v_perm_b32 v73, v87, v85, s100
  v_perm_b32 v77, v87, v85, s101
  v_perm_b32 v66, v90, v88, s100
  v_perm_b32 v70, v90, v88, s101
  v_perm_b32 v74, v91, v89, s100
  v_perm_b32 v78, v91, v89, s101
  v_perm_b32 v67, v94, v92, s100
  v_perm_b32 v71, v94, v92, s101
  v_perm_b32 v75, v95, v93, s100
  v_perm_b32 v79, v95, v93, s101
  s_nop 1
  v_mfma_f32_16x16x32_bf16 v[144:147], v[16:19], v[64:67], v[144:147]
  v_mfma_f32_16x16x32_bf16 v[148:151], v[16:19], v[68:71], v[148:151]
  v_mfma_f32_16x16x32_bf16 v[152:155], v[16:19], v[72:75], v[152:155]
  v_mfma_f32_16x16x32_bf16 v[156:159], v[16:19], v[76:79], v[156:159]
  s_waitcnt vmcnt(8)
  v_perm_b32 v80, v98, v96, s100
  v_perm_b32 v84, v98, v96, s101
  v_perm_b32 v88, v99, v97, s100
  v_perm_b32 v92, v99, v97, s101
  v_perm_b32 v81, v102, v100, s100
  v_perm_b32 v85, v102, v100, s101
  v_perm_b32 v89, v103, v101, s100
  v_perm_b32 v93, v103, v101, s101
  v_perm_b32 v82, v106, v104, s100
  v_perm_b32 v86, v106, v104, s101
  v_perm_b32 v90, v107, v105, s100
  v_perm_b32 v94, v107, v105, s101
  v_perm_b32 v83, v110, v108, s100
  v_perm_b32 v87, v110, v108, s101
  v_perm_b32 v91, v111, v109, s100
  v_perm_b32 v95, v111, v109, s101
  s_nop 1
  v_mfma_f32_16x16x32_bf16 v[144:147], v[20:23], v[80:83], v[144:147]
  v_mfma_f32_16x16x32_bf16 v[148:151], v[20:23], v[84:87], v[148:151]
  v_mfma_f32_16x16x32_bf16 v[152:155], v[20:23], v[88:91], v[152:155]
  v_mfma_f32_16x16x32_bf16 v[156:159], v[20:23], v[92:95], v[156:159]
  s_waitcnt vmcnt(0)
  v_perm_b32 v96, v114, v112, s100
  v_perm_b32 v100, v114, v112, s101
  v_perm_b32 v104, v115, v113, s100
  v_perm_b32 v108, v115, v113, s101
  v_perm_b32 v97, v118, v116, s100
  v_perm_b32 v101, v118, v116, s101
  v_perm_b32 v105, v119, v117, s100
  v_perm_b32 v109, v119, v117, s101
  v_perm_b32 v98, v122, v120, s100
  v_perm_b32 v102, v122, v120, s101
  v_perm_b32 v106, v123, v121, s100
  v_perm_b32 v110, v123, v121, s101
  v_perm_b32 v99, v126, v124, s100
  v_perm_b32 v103, v126, v124, s101
  v_perm_b32 v107, v127, v125, s100
  v_perm_b32 v111, v127, v125, s101
  s_nop 1
  v_mfma_f32_16x16x32_bf16 v[144:147], v[24:27], v[96:99], v[144:147]
  v_mfma_f32_16x16x32_bf16 v[148:151], v[24:27], v[100:103], v[148:151]
  v_mfma_f32_16x16x32_bf16 v[152:155], v[24:27], v[104:107], v[152:155]
  v_mfma_f32_16x16x32_bf16 v[156:159], v[24:27], v[108:111], v[156:159]
  s_mov_b32 s29, 65536
L_lw_117:
  ds_read_b64 v[24:25], v1 offset:224
  s_waitcnt lgkmcnt(0)
  v_min_u32 v24, v24, v25
  s_sub_u32 s29, s29, 1
  v_readfirstlane_b32 s40, v24
  s_cbranch_scc1 L_lwo_118
  s_cmp_ge_u32 s40, 3
  s_cbranch_scc1 L_lwo_118
  s_sleep 2
  s_branch L_lw_117
L_lwo_118:
  v_lshlrev_b32 v28, 4, v0
  s_nop 0
  s_lshl_b32 s40, s62, 2
  s_add_u32 s40, s40, s63
  s_lshl_b32 s40, s40, 9
  s_add_u32 s40, s40, 790528
  v_mov_b32 v9, s28
  v_mov_b32 v11, s28
  s_nop 1
  v_cndmask_b32 v8, v144, v152, s[56:57]
  v_cndmask_b32 v10, v148, v156, s[56:57]
  s_mov_b32 exec_hi, 0
  buffer_store_dwordx4 v[8:11], v28, s[4:7], s40 offen sc1
  s_mov_b64 exec, -1
  s_branch L_FFNe
L_FFN2:
  s_mul_i32 s40, s63, 37
  s_add_u32 s40, s40, s62
  s_sub_u32 s58, s40, 27
  s_cmp_lt_u32 s58, 135
  s_cbranch_scc1 L_FFN2a
  s_mov_b32 s29, 65536
L_w_119:
  ds_read_b32 v3, v1 offset:44
  ds_read_b32 v6, v1 offset:40
  s_waitcnt lgkmcnt(0)
  v_readfirstlane_b32 s28, v3
  s_sub_u32 s29, s29, 1
  s_cbranch_scc1 L_wo_120
  s_cmp_ge_u32 s28, 1
  s_cbranch_scc0 L_w_119
L_wo_120:
  v_readfirstlane_b32 s28, v6
  s_branch L_FFNe
L_FFN2a:
  s_mul_i32 s59, s58, 205
  s_lshr_b32 s59, s59, 10
  s_mul_i32 s60, s59, 5
  s_sub_u32 s60, s58, s60
  v_mul_u32_u24 v28, 10240, v5
  v_lshl_add_u32 v28, v4, 3, v28
  s_mul_i32 s58, s59, 81920
  s_lshl_b32 s41, s60, 8
  s_add_u32 s58, s58, s41
  s_mov_b32 s8, s32
  s_mov_b32 s9, s33
  s_mov_b32 s10, 2211840
  s_mov_b32 s11, 0x20000
  s_add_u32 s41, s58, 0
  s_waitcnt vmcnt(31)
  buffer_load_dwordx2 v[48:49], v28, s[8:11], s41 offen nt
  s_waitcnt vmcnt(31)
  buffer_load_dwordx2 v[50:51], v28, s[8:11], s41 offen offset:1280 nt
  s_waitcnt vmcnt(31)
  buffer_load_dwordx2 v[52:53], v28, s[8:11], s41 offen offset:2560 nt
  s_waitcnt vmcnt(31)
  buffer_load_dwordx2 v[54:55], v28, s[8:11], s41 offen offset:3840 nt
  s_add_u32 s42, s41, 5120
  s_waitcnt vmcnt(31)
  buffer_load_dwordx2 v[56:57], v28, s[8:11], s42 offen nt
  s_waitcnt vmcnt(31)
  buffer_load_dwordx2 v[58:59], v28, s[8:11], s42 offen offset:1280 nt
  s_waitcnt vmcnt(31)
  buffer_load_dwordx2 v[60:61], v28, s[8:11], s42 offen offset:2560 nt
  s_waitcnt vmcnt(31)
  buffer_load_dwordx2 v[62:63], v28, s[8:11], s42 offen offset:3840 nt
  s_add_u32 s41, s58, 40960
  s_waitcnt vmcnt(31)
  buffer_load_dwordx2 v[64:65], v28, s[8:11], s41 offen nt
  s_waitcnt vmcnt(31)
  buffer_load_dwordx2 v[66:67], v28, s[8:11], s41 offen offset:1280 nt
  s_waitcnt vmcnt(31)
  buffer_load_dwordx2 v[68:69], v28, s[8:11], s41 offen offset:2560 nt
  s_waitcnt vmcnt(31)
  buffer_load_dwordx2 v[70:71], v28, s[8:11], s41 offen offset:3840 nt
  s_add_u32 s42, s41, 5120
  s_waitcnt vmcnt(31)
  buffer_load_dwordx2 v[72:73], v28, s[8:11], s42 offen nt
  s_waitcnt vmcnt(31)
  buffer_load_dwordx2 v[74:75], v28, s[8:11], s42 offen offset:1280 nt
  s_waitcnt vmcnt(31)
  buffer_load_dwordx2 v[76:77], v28, s[8:11], s42 offen offset:2560 nt
  s_waitcnt vmcnt(31)
  buffer_load_dwordx2 v[78:79], v28, s[8:11], s42 offen offset:3840 nt
  s_add_u32 s41, s58, 128
  s_waitcnt vmcnt(31)
  buffer_load_dwordx2 v[80:81], v28, s[8:11], s41 offen nt
  s_waitcnt vmcnt(31)
  buffer_load_dwordx2 v[82:83], v28, s[8:11], s41 offen offset:1280 nt
  s_waitcnt vmcnt(31)
  buffer_load_dwordx2 v[84:85], v28, s[8:11], s41 offen offset:2560 nt
  s_waitcnt vmcnt(31)
  buffer_load_dwordx2 v[86:87], v28, s[8:11], s41 offen offset:3840 nt
  s_add_u32 s42, s41, 5120
  s_waitcnt vmcnt(31)
  buffer_load_dwordx2 v[88:89], v28, s[8:11], s42 offen nt
  s_waitcnt vmcnt(31)
  buffer_load_dwordx2 v[90:91], v28, s[8:11], s42 offen offset:1280 nt
  s_waitcnt vmcnt(31)
  buffer_load_dwordx2 v[92:93], v28, s[8:11], s42 offen offset:2560 nt
  s_waitcnt vmcnt(31)
  buffer_load_dwordx2 v[94:95], v28, s[8:11], s42 offen offset:3840 nt
  s_add_u32 s41, s58, 41088
  s_waitcnt vmcnt(31)
  buffer_load_dwordx2 v[96:97], v28, s[8:11], s41 offen nt
  s_waitcnt vmcnt(31)
  buffer_load_dwordx2 v[98:99], v28, s[8:11], s41 offen offset:1280 nt
  s_waitcnt vmcnt(31)
  buffer_load_dwordx2 v[100:101], v28, s[8:11], s41 offen offset:2560 nt
  s_waitcnt vmcnt(31)
  buffer_load_dwordx2 v[102:103], v28, s[8:11], s41 offen offset:3840 nt
  s_add_u32 s42, s41, 5120
  s_waitcnt vmcnt(31)
  buffer_load_dwordx2 v[104:105], v28, s[8:11], s42 offen nt
  s_waitcnt vmcnt(31)
  buffer_load_dwordx2 v[106:107], v28, s[8:11], s42 offen offset:1280 nt
  s_waitcnt vmcnt(31)
  buffer_load_dwordx2 v[108:109], v28, s[8:11], s42 offen offset:2560 nt
  s_waitcnt vmcnt(31)
  buffer_load_dwordx2 v[110:111], v28, s[8:11], s42 offen offset:3840 nt
  s_mov_b32 s29, 65536
L_w_121:
  ds_read_b32 v3, v1 offset:44
  ds_read_b32 v6, v1 offset:40
  s_waitcnt lgkmcnt(0)
  v_readfirstlane_b32 s28, v3
  s_sub_u32 s29, s29, 1
  s_cbranch_scc1 L_wo_122
  s_cmp_ge_u32 s28, 1
  s_cbranch_scc0 L_w_121
L_wo_122:
  v_readfirstlane_b32 s28, v6
  s_waitcnt vmcnt(24)
  v_perm_b32 v32, v50, v48, s100
  v_perm_b32 v36, v50, v48, s101
  v_perm_b32 v40, v51, v49, s100
  v_perm_b32 v44, v51, v49, s101
  v_perm_b32 v33, v54, v52, s100
  v_perm_b32 v37, v54, v52, s101
  v_perm_b32 v41, v55, v53, s100
  v_perm_b32 v45, v55, v53, s101
  v_perm_b32 v34, v58, v56, s100
  v_perm_b32 v38, v58, v56, s101
  v_perm_b32 v42, v59, v57, s100
  v_perm_b32 v46, v59, v57, s101
  v_perm_b32 v35, v62, v60, s100
  v_perm_b32 v39, v62, v60, s101
  v_perm_b32 v43, v63, v61, s100
  v_perm_b32 v47, v63, v61, s101
  s_waitcnt vmcnt(16)
  v_perm_b32 v48, v66, v64, s100
  v_perm_b32 v52, v66, v64, s101
  v_perm_b32 v56, v67, v65, s100
  v_perm_b32 v60, v67, v65, s101
  v_perm_b32 v49, v70, v68, s100
  v_perm_b32 v53, v70, v68, s101
  v_perm_b32 v57, v71, v69, s100
  v_perm_b32 v61, v71, v69, s101
  v_perm_b32 v50, v74, v72, s100
  v_perm_b32 v54, v74, v72, s101
  v_perm_b32 v58, v75, v73, s100
  v_perm_b32 v62, v75, v73, s101
  v_perm_b32 v51, v78, v76, s100
  v_perm_b32 v55, v78, v76, s101
  v_perm_b32 v59, v79, v77, s100
  v_perm_b32 v63, v79, v77, s101
  s_waitcnt vmcnt(8)
  v_perm_b32 v64, v82, v80, s100
  v_perm_b32 v68, v82, v80, s101
  v_perm_b32 v72, v83, v81, s100
  v_perm_b32 v76, v83, v81, s101
  v_perm_b32 v65, v86, v84, s100
  v_perm_b32 v69, v86, v84, s101
  v_perm_b32 v73, v87, v85, s100
  v_perm_b32 v77, v87, v85, s101
  v_perm_b32 v66, v90, v88, s100
  v_perm_b32 v70, v90, v88, s101
  v_perm_b32 v74, v91, v89, s100
  v_perm_b32 v78, v91, v89, s101
  v_perm_b32 v67, v94, v92, s100
  v_perm_b32 v71, v94, v92, s101
  v_perm_b32 v75, v95, v93, s100
  v_perm_b32 v79, v95, v93, s101
  s_waitcnt vmcnt(0)
  v_perm_b32 v80, v98, v96, s100
  v_perm_b32 v84, v98, v96, s101
  v_perm_b32 v88, v99, v97, s100
  v_perm_b32 v92, v99, v97, s101
  v_perm_b32 v81, v102, v100, s100
  v_perm_b32 v85, v102, v100, s101
  v_perm_b32 v89, v103, v101, s100
  v_perm_b32 v93, v103, v101, s101
  v_perm_b32 v82, v106, v104, s100
  v_perm_b32 v86, v106, v104, s101
  v_perm_b32 v90, v107, v105, s100
  v_perm_b32 v94, v107, v105, s101
  v_perm_b32 v83, v110, v108, s100
  v_perm_b32 v87, v110, v108, s101
  v_perm_b32 v91, v111, v109, s100
  v_perm_b32 v95, v111, v109, s101
  v_lshrrev_b32 v28, 2, v4
  v_lshlrev_b32 v28, 9, v28
  v_lshl_add_u32 v28, v5, 5, v28
  v_bfe_u32 v29, v4, 1, 1
  v_lshl_add_u32 v28, v29, 4, v28
  v_and_b32 v29, 1, v4
  v_lshl_add_u32 v28, v29, 8, v28
  s_lshl_b32 s40, s59, 11
  s_add_u32 s40, s40, 790528
  s_mov_b32 s29, 65536
  s_branch L_wf_125
L_w_123:
  s_sleep 2
L_wf_125:
  ds_read_b32 v3, v1 offset:20
  s_waitcnt lgkmcnt(0)
  v_readfirstlane_b32 s41, v3
  s_sub_u32 s29, s29, 1
  s_cbranch_scc1 L_wo_124
  s_cmp_ge_u32 s41, 8
  s_cbranch_scc0 L_w_123
L_wo_124:
  s_mov_b32 s43, 8192
L_h6_126:
  buffer_load_dwordx4 v[8:11], v28, s[4:7], s40 offen sc1
  buffer_load_dwordx4 v[12:15], v28, s[4:7], s40 offen offset:128 sc1
  s_waitcnt vmcnt(0)
  v_xor_b32 v3, s28, v9
  v_bitop3_b32 v3, v11, s28, v3 bitop3:0xbe
  v_bitop3_b32 v3, v13, s28, v3 bitop3:0xbe
  v_bitop3_b32 v3, v15, s28, v3 bitop3:0xbe
  v_cmp_ne_u32 vcc, 0, v3
  s_cbranch_vccz L_h6o_127
  s_mov_b64 exec, vcc
  s_sleep 6
  s_sub_u32 s43, s43, 1
  s_cbranch_scc0 L_h6_126
L_h6o_127:
  s_mov_b64 exec, -1
  v_add_f32_dpp v8, v8, v8 row_ror:4 row_mask:0xf bank_mask:0xf
  v_add_f32_dpp v10, v10, v10 row_ror:4 row_mask:0xf bank_mask:0xf
  v_add_f32_dpp v12, v12, v12 row_ror:4 row_mask:0xf bank_mask:0xf
  v_add_f32_dpp v14, v14, v14 row_ror:4 row_mask:0xf bank_mask:0xf
  v_add_f32_dpp v8, v8, v8 row_ror:8 row_mask:0xf bank_mask:0xf
  v_add_f32_dpp v10, v10, v10 row_ror:8 row_mask:0xf bank_mask:0xf
  v_add_f32_dpp v12, v12, v12 row_ror:8 row_mask:0xf bank_mask:0xf
  v_add_f32_dpp v14, v14, v14 row_ror:8 row_mask:0xf bank_mask:0xf
  v_max_f32 v8, 0, v8
  v_max_f32 v10, 0, v10
  v_max_f32 v12, 0, v12
  v_max_f32 v14, 0, v14
  v_cvt_pk_bf16_f32 v8, v8, v10
  v_cvt_pk_bf16_f32 v12, v12, v14
  s_nop 1
  v_mov_b32_dpp v16, v8 quad_perm:[0,0,0,0] row_mask:0xf bank_mask:0xf
  v_mov_b32_dpp v17, v8 quad_perm:[1,1,1,1] row_mask:0xf bank_mask:0xf
  v_mov_b32_dpp v18, v8 quad_perm:[2,2,2,2] row_mask:0xf bank_mask:0xf
  v_mov_b32_dpp v19, v8 quad_perm:[3,3,3,3] row_mask:0xf bank_mask:0xf
  v_mov_b32_dpp v20, v12 quad_perm:[0,0,0,0] row_mask:0xf bank_mask:0xf
  v_mov_b32_dpp v21, v12 quad_perm:[1,1,1,1] row_mask:0xf bank_mask:0xf
  v_mov_b32_dpp v22, v12 quad_perm:[2,2,2,2] row_mask:0xf bank_mask:0xf
  v_mov_b32_dpp v23, v12 quad_perm:[3,3,3,3] row_mask:0xf bank_mask:0xf
  s_nop 1
  v_mfma_f32_16x16x32_bf16 v[96:99], v[16:19], v[32:35], 0
  v_mfma_f32_16x16x32_bf16 v[100:103], v[16:19], v[36:39], 0
  v_mfma_f32_16x16x32_bf16 v[104:107], v[16:19], v[40:43], 0
  v_mfma_f32_16x16x32_bf16 v[108:111], v[16:19], v[44:47], 0
  v_mfma_f32_16x16x32_bf16 v[96:99], v[20:23], v[48:51], v[96:99]
  v_mfma_f32_16x16x32_bf16 v[100:103], v[20:23], v[52:55], v[100:103]
  v_mfma_f32_16x16x32_bf16 v[104:107], v[20:23], v[56:59], v[104:107]
  v_mfma_f32_16x16x32_bf16 v[108:111], v[20:23], v[60:63], v[108:111]
  v_mfma_f32_16x16x32_bf16 v[112:115], v[16:19], v[64:67], 0
  v_mfma_f32_16x16x32_bf16 v[116:119], v[16:19], v[68:71], 0
  v_mfma_f32_16x16x32_bf16 v[120:123], v[16:19], v[72:75], 0
  v_mfma_f32_16x16x32_bf16 v[124:127], v[16:19], v[76:79], 0
  v_mfma_f32_16x16x32_bf16 v[112:115], v[20:23], v[80:83], v[112:115]
  v_mfma_f32_16x16x32_bf16 v[116:119], v[20:23], v[84:87], v[116:119]
  v_mfma_f32_16x16x32_bf16 v[120:123], v[20:23], v[88:91], v[120:123]
  v_mfma_f32_16x16x32_bf16 v[124:127], v[20:23], v[92:95], v[124:127]
  v_lshrrev_b32 v28, 3, v4
  v_lshlrev_b32 v28, 12, v28
  v_and_b32 v29, 7, v4
  v_lshl_add_u32 v28, v29, 4, v28
  v_mov_b32 v29, 0xff
  s_lshl_b32 s40, s60, 14
  s_lshl_b32 s41, s59, 7
  s_add_u32 s40, s40, s41
  s_add_u32 s40, s40, 856064
  s_add_u32 s41, s40, 8192
  s_and_b32 s66, s28, 1
  s_mul_i32 s66, s66, 0x01010101
  s_and_b32 s67, s28, 0xfefefefe
  s_or_b32 s66, s66, s67
  s_bfe_u32 s67, s66, 0x80008
  s_bfe_u32 s68, s66, 0x80010
  s_lshr_b32 s69, s66, 24
  s_and_b32 s66, s66, 0xff
  v_bfi_b32 v8, v29, s66, v96
  v_bfi_b32 v9, v29, s67, v100
  v_bfi_b32 v10, v29, s68, v104
  v_bfi_b32 v11, v29, s69, v108
  v_bfi_b32 v12, v29, s66, v112
  v_bfi_b32 v13, v29, s67, v116
  v_bfi_b32 v14, v29, s68, v120
  v_bfi_b32 v15, v29, s69, v124
  s_mov_b64 exec, 0xffff
  buffer_store_dwordx4 v[8:11], v28, s[4:7], s40 offen sc1
  buffer_store_dwordx4 v[12:15], v28, s[4:7], s41 offen sc1
  s_mov_b64 exec, -1
L_FFNe:
  v_mul_u32_u24 v6, 10240, v5
  v_lshl_add_u32 v6, v4, 3, v6
  s_lshl_b32 s40, s14, 7
  s_lshr_b32 s41, s15, 1
  s_lshl_b32 s41, s41, 5
  s_add_u32 s40, s40, s41
  s_mul_i32 s40, s40, 1280
  s_and_b32 s41, s15, 1
  s_mul_i32 s41, s41, 640
  s_add_u32 s48, s40, s41
  s_mov_b32 s44, s26
  s_mov_b32 s45, s27
  s_mov_b32 s46, 5242880
  s_mov_b32 s47, 0x20000
  v_and_b32 v31, 7, v4
  v_lshlrev_b32 v29, 7, v31
  v_lshl_add_u32 v29, v5, 5, v29
  s_lshl_b32 s50, s14, 2
  s_lshr_b32 s51, s15, 1
  s_add_u32 s50, s50, s51
  s_lshl_b32 s61, s50, 10
  s_add_u32 s61, s61, 659456
  v_lshrrev_b32 v30, 3, v4
  v_lshlrev_b32 v30, 14, v30
  v_lshl_add_u32 v30, v31, 4, v30
  v_mov_b32 v31, 0xff
  s_and_b32 s41, s15, 1
  s_mul_i32 s41, s41, 163840
  s_lshl_b32 s50, s50, 7
  s_add_u32 s50, s50, s41
  s_add_u32 s50, s50, 937984
  s_and_b32 s66, s28, 1
  s_mul_i32 s66, s66, 0x01010101
  s_and_b32 s67, s28, 0xfefefefe
  s_or_b32 s66, s66, s67
  s_bfe_u32 s67, s66, 0x80008
  s_bfe_u32 s68, s66, 0x80010
  s_lshr_b32 s69, s66, 24
  s_and_b32 s66, s66, 0xff
  s_add_u32 s49, s48, 512
  s_mov_b32 s29, 65536
  s_branch L_wf_130
L_w_128:
  s_sleep 2
L_wf_130:
  ds_read_b32 v3, v1 offset:12
  s_waitcnt lgkmcnt(0)
  v_readfirstlane_b32 s40, v3
  s_sub_u32 s29, s29, 1
  s_cbranch_scc1 L_wo_129
  s_cmp_ge_u32 s40, 2
  s_cbranch_scc0 L_w_128
L_wo_129:
  s_waitcnt vmcnt(31)
  buffer_load_dwordx2 v[128:129], v6, s[44:47], s49 offen nt
  s_waitcnt vmcnt(31)
  buffer_load_dwordx2 v[130:131], v6, s[44:47], s49 offen offset:1280 nt
  s_waitcnt vmcnt(31)
  buffer_load_dwordx2 v[132:133], v6, s[44:47], s49 offen offset:2560 nt
  s_waitcnt vmcnt(31)
  buffer_load_dwordx2 v[134:135], v6, s[44:47], s49 offen offset:3840 nt
  s_add_u32 s42, s49, 5120
  s_waitcnt vmcnt(31)
  buffer_load_dwordx2 v[136:137], v6, s[44:47], s42 offen nt
  s_waitcnt vmcnt(31)
  buffer_load_dwordx2 v[138:139], v6, s[44:47], s42 offen offset:1280 nt
  s_waitcnt vmcnt(31)
  buffer_load_dwordx2 v[140:141], v6, s[44:47], s42 offen offset:2560 nt
  s_waitcnt vmcnt(31)
  buffer_load_dwordx2 v[142:143], v6, s[44:47], s42 offen offset:3840 nt
  s_waitcnt vmcnt(0)
  v_perm_b32 v32, v130, v128, s100
  v_perm_b32 v36, v130, v128, s101
  v_perm_b32 v40, v131, v129, s100
  v_perm_b32 v44, v131, v129, s101
  v_perm_b32 v33, v138, v136, s100
  v_perm_b32 v37, v138, v136, s101
  v_perm_b32 v41, v139, v137, s100
  v_perm_b32 v45, v139, v137, s101
  v_perm_b32 v34, v134, v132, s100
  v_perm_b32 v38, v134, v132, s101
  v_perm_b32 v42, v135, v133, s100
  v_perm_b32 v46, v135, v133, s101
  v_perm_b32 v35, v142, v140, s100
  v_perm_b32 v39, v142, v140, s101
  v_perm_b32 v43, v143, v141, s100
  v_perm_b32 v47, v143, v141, s101
  buffer_load_dwordx4 v[8:11], v29, s[4:7], s61 offen sc1
  s_add_u32 s51, s50, 131072
  buffer_load_dwordx4 v[12:15], v30, s[4:7], s51 offen sc1
  s_mov_b32 s29, 65536
  s_branch L_wf_133
L_w_131:
  s_sleep 2
L_wf_133:
  ds_read_b32 v3, v1 offset:220
  s_waitcnt lgkmcnt(0)
  v_readfirstlane_b32 s40, v3
  s_sub_u32 s29, s29, 1
  s_cbranch_scc1 L_wo_132
  s_cmp_ge_u32 s40, 8
  s_cbranch_scc0 L_w_131
L_wo_132:
  s_mov_b32 s29, 65536
L_w_134:
  ds_read_b32 v3, v1 offset:212
  ds_read_b32 v28, v1 offset:216
  s_waitcnt lgkmcnt(0)
  v_readfirstlane_b32 s40, v3
  s_sub_u32 s29, s29, 1
  s_cbranch_scc1 L_wo_135
  s_cmp_ge_u32 s40, 1
  s_cbranch_scc0 L_w_134
L_wo_135:
  s_mov_b32 s29, 65536
  s_branch L_wf_138
L_w_136:
  s_sleep 1
L_wf_138:
  ds_read_b32 v3, v1 offset:32
  s_waitcnt lgkmcnt(0)
  v_readfirstlane_b32 s40, v3
  s_sub_u32 s29, s29, 1
  s_cbranch_scc1 L_wo_137
  s_cmp_ge_u32 s40, 8
  s_cbranch_scc0 L_w_136
L_wo_137:
  s_setprio 2
  s_mov_b32 s43, 8192
L_h4_140:
  buffer_load_dwordx4 v[8:11], v29, s[4:7], s61 offen sc1
  buffer_load_dwordx4 v[12:15], v29, s[4:7], s61 offen offset:16 sc1
  s_waitcnt vmcnt(0)
  v_xor_b32 v3, s28, v9
  v_bitop3_b32 v3, v11, s28, v3 bitop3:0xbe
  v_bitop3_b32 v3, v13, s28, v3 bitop3:0xbe
  v_bitop3_b32 v3, v15, s28, v3 bitop3:0xbe
  v_cmp_ne_u32 vcc, 0, v3
  s_cbranch_vccz L_h4o_141
  s_mov_b64 exec, vcc
  s_sub_u32 s43, s43, 1
  s_cbranch_scc0 L_h4_140
L_h4o_141:
  s_mov_b64 exec, -1
  v_mov_b32 v9, v12
  v_mov_b32 v11, v14
  s_nop 1
  v_mfma_f32_16x16x32_bf16 v[48:51], v[8:11], v[32:35], 0
  v_mfma_f32_16x16x32_bf16 v[52:55], v[8:11], v[36:39], 0
  v_mfma_f32_16x16x32_bf16 v[56:59], v[8:11], v[40:43], 0
  v_mfma_f32_16x16x32_bf16 v[60:63], v[8:11], v[44:47], 0
  s_nop 4
  v_pk_add_f32 v[48:49], v[48:49], v[50:51]
  v_pk_add_f32 v[52:53], v[52:53], v[54:55]
  v_pk_add_f32 v[56:57], v[56:57], v[58:59]
  v_pk_add_f32 v[60:61], v[60:61], v[62:63]
  v_add_f32 v16, v48, v49
  v_add_f32 v17, v52, v53
  v_add_f32 v18, v56, v57
  v_add_f32 v19, v60, v61
  v_mov_b32 v20, v16
  v_mov_b32 v21, v17
  v_mov_b32 v22, v18
  v_mov_b32 v23, v19
  s_add_u32 s51, s50, 131072
  v_permlane16_swap_b32 v16, v20
  v_permlane16_swap_b32 v17, v21
  v_permlane16_swap_b32 v18, v22
  v_permlane16_swap_b32 v19, v23
  v_pk_add_f32 v[16:17], v[16:17], v[20:21]
  v_pk_add_f32 v[18:19], v[18:19], v[22:23]
  v_mul_f32 v48, v16, v28
  v_mul_f32 v49, v17, v28
  v_mul_f32 v50, v18, v28
  v_mul_f32 v51, v19, v28
  v_bfi_b32 v48, v31, s66, v48
  v_bfi_b32 v49, v31, s67, v49
  v_bfi_b32 v50, v31, s68, v50
  v_bfi_b32 v51, v31, s69, v51
  s_mov_b64 exec, 0xffff
  buffer_store_dwordx4 v[48:51], v30, s[4:7], s51 offen sc1
  s_mov_b64 exec, -1
  s_mov_b64 exec, 1
  ds_add_u32 v1, v2 offset:56
  s_mov_b64 exec, -1
L_G_end:
L_END:
  s_endpgm
.p2align 12
L_CODE_END:
.section .rodata,"a"
.p2align 6
.amdhsa_kernel recurrent_scan__compressed_kv_cla__dense_activation_relu__decode_kernel
  .amdhsa_next_free_vgpr 168
  .amdhsa_next_free_sgpr 102
  .amdhsa_accum_offset 168
  .amdhsa_group_segment_fixed_size 0
  .amdhsa_kernarg_size 96
  .amdhsa_user_sgpr_count 2
  .amdhsa_user_sgpr_kernarg_segment_ptr 1
  .amdhsa_system_sgpr_workgroup_id_x 1
.end_amdhsa_kernel
```
